```python
import torch

def _softmax(x, axis=-1):
    return torch.softmax(x, dim=axis)
def _gelu(x):
    return torch.nn.functional.gelu(x, approximate="tanh")
def _silu(x):
    return torch.nn.functional.silu(x)
def _sigmoid(x):
    return torch.sigmoid(x)
def _layernorm(x, axis=-1, eps=1e-5):
    m = x.mean(dim=axis, keepdim=True)
    v = x.var(dim=axis, keepdim=True, unbiased=False)
    return (x - m) / torch.sqrt(v + eps)
def _scatter_add(tgt, idx, src, axis=0):
    return tgt.clone().index_add_(axis, idx, src)
def _segment_sum(src, seg, n):
    out = torch.zeros((n,) + src.shape[1:], dtype=src.dtype)
    return out.index_add_(0, seg, src)
def _pad(x, pw):
    flat = tuple(v for pair in reversed(pw) for v in pair)
    return torch.nn.functional.pad(x, flat)

kernel_name = 'parallel_sum__ssm_conv_s4d__mixer_channel_mlp__prompt'

def setup_inputs():

    _w = (lambda a: (lambda t: t.to(torch.bfloat16) if t.is_floating_point() else t)(torch.as_tensor(a)))
    def _A_setup():
        Bsz, L, D, N = 1, 2048, 640, 192
        return {
            "u": _w((lambda *s: torch.randn(*s, dtype=torch.bfloat16) * 0.05)(Bsz, L, D)),
            "log_A_real": _w((lambda *s: torch.randn(*s, dtype=torch.bfloat16) * 3.2)(D, N) * 0.5),
            "A_imag": _w((lambda *s: torch.randn(*s, dtype=torch.bfloat16) * 0.05)(D, N) * 3.14),
            "C_real": _w((lambda *s: torch.randn(*s, dtype=torch.bfloat16) * 0.1)(D, N) / N ** 0.5),
            "C_imag": _w((lambda *s: torch.randn(*s, dtype=torch.bfloat16) * 0.2)(D, N) / N ** 0.5),
            "log_dt": _w((lambda *s: torch.randn(*s, dtype=torch.bfloat16) * 0.05)(D) * 0.5 - 4.0),
            "D_skip": _w((lambda *s: torch.randn(*s, dtype=torch.bfloat16) * 0.05)(D)),
        }
    _A_in = _A_setup()

    def _B_setup():
        B, S, D, F = 1, 2048, 640, 1536
        return {
            "x": _w((lambda *s: torch.randn(*s, dtype=torch.bfloat16) * 0.05)(B, S, D)),
            "w1": _w((lambda *s: torch.randn(*s, dtype=torch.bfloat16) * 1.6)(D, F) * (D ** -0.5)),
            "b1": _w((lambda *s: torch.randn(*s, dtype=torch.bfloat16) * 0.8)(F)),
            "w2": _w((lambda *s: torch.randn(*s, dtype=torch.bfloat16) * 0.05)(F, D) * (F ** -0.5)),
            "b2": _w((lambda *s: torch.randn(*s, dtype=torch.bfloat16) * 0.05)(D)),
        }
    _B_in = _B_setup()

    return {
        "A_u": _A_in["u"],
        "A_log_A_real": _A_in["log_A_real"],
        "A_A_imag": _A_in["A_imag"],
        "A_C_real": _A_in["C_real"],
        "A_C_imag": _A_in["C_imag"],
        "A_log_dt": _A_in["log_dt"],
        "A_D_skip": _A_in["D_skip"],
        "B_x": _B_in["x"],
        "B_w1": _B_in["w1"],
        "B_b1": _B_in["b1"],
        "B_w2": _B_in["w2"],
        "B_b2": _B_in["b2"],
    }

def reference(A_u, A_log_A_real, A_A_imag, A_C_real, A_C_imag, A_log_dt, A_D_skip, B_x, B_w1, B_b1, B_w2, B_b2):
    def _A_ref(u, log_A_real, A_imag, C_real, C_imag, log_dt, D_skip):
        L = u.shape[1]
        dt = torch.exp(log_dt)
        A = -torch.exp(log_A_real) + 1j * A_imag
        C = (C_real + 1j * C_imag) * dt[:, None]
        pos = (lambda x, dt: x.to(dt))(torch.arange(L), log_dt.dtype)
        P = torch.exp((A * dt[:, None])[:, :, None] * pos[None, None, :])
        K = 2.0 * torch.einsum("dn,dnl->dl", C, P).real
        L2 = 2 * L
        u_t = (lambda x, *d: x.permute(*d))(u, 0, 2, 1)
        Kf = (lambda x, *a, **k: torch.fft.rfft(x.float(), *a, **k))(K, L2)
        Uf = (lambda x, *a, **k: torch.fft.rfft(x.float(), *a, **k))(u_t, L2)
        y = (lambda x, *a, **k: torch.fft.irfft(x, *a, **k).to(torch.bfloat16))(Uf * Kf[None, :, :], L2)[:, :, :L]
        y = (lambda x, *d: x.permute(*d))(y, 0, 2, 1)
        return y + u * D_skip[None, None, :]

    def _B_ref(x, w1, b1, w2, b2):
        y = _layernorm(x, axis=-1)
        h = _gelu(torch.einsum("bsd,df->bsf", y, w1) + b1)
        return torch.einsum("bsf,fd->bsd", h, w2) + b2

    x = A_u
    xn = _layernorm(x, axis=-1)
    return x + _A_ref(xn, A_log_A_real, A_A_imag, A_C_real, A_C_imag, A_log_dt, A_D_skip) + _B_ref(xn, B_w1, B_b1, B_w2, B_b2)
```

```asm
; @launch grid=(256,1,1) block=(512,1,1) lds=163840
.amdgcn_target "amdgcn-amd-amdhsa--gfx950"
.text
.globl parallel_sum__ssm_conv_s4d__mixer_channel_mlp__prompt_kernel
.p2align 8
.type parallel_sum__ssm_conv_s4d__mixer_channel_mlp__prompt_kernel,@function
parallel_sum__ssm_conv_s4d__mixer_channel_mlp__prompt_kernel:
  s_load_dwordx16 s[16:31], s[0:1], 0
  s_load_dwordx8 s[32:39], s[0:1], 64
  s_load_dwordx4 s[40:43], s[0:1], 96
  s_load_dwordx2 s[44:45], s[0:1], 112
  s_cmp_ge_u32 s2, 256
  s_cbranch_scc1 K_end
  v_lshrrev_b32 v1, 6, v0
  v_and_b32 v0, 63, v0
  s_and_b32 s7, s2, 7
  v_readfirstlane_b32 s3, v1
  s_lshr_b32 s8, s2, 3
  s_lshr_b32 s9, s7, 1
  s_lshl_b32 s9, s9, 3
  s_and_b32 s10, s8, 7
  s_add_u32 s4, s9, s10
  s_and_b32 s9, s7, 1
  s_lshl_b32 s9, s9, 2
  s_lshr_b32 s10, s8, 3
  s_add_u32 s5, s9, s10
  s_cmp_lt_u32 s3, 4
  s_cbranch_scc1 K_g
  s_setprio 3
  s_cmp_eq_u32 s3, 7
  s_cbranch_scc1 K_l
  s_sub_u32 s60, s3, 4
  s_mul_i32 s62, s4, 5
  s_add_u32 s62, s62, 1
  s_lshr_b32 s62, s62, 1
  s_mul_i32 s63, s5, 80
  s_add_u32 s62, s62, s63
  s_add_u32 s62, s62, s60
  s_mul_i32 s65, s62, 384
  v_lshl_add_u32 v8, v0, 2, s65
  v_lshl_add_u32 v9, v0, 1, s65
  s_lshr_b32 s66, s62, 1
  s_lshl_b32 s66, s66, 2
  s_and_b32 s63, s4, 1
  s_add_u32 s63, s63, s60
  s_cmp_eq_u32 s63, 3
  s_waitcnt lgkmcnt(0)
  s_cbranch_scc1 R_p
  global_load_dword v36, v8, s[18:19]
  global_load_ushort v40, v9, s[18:19] offset:256
  global_load_dword v37, v8, s[20:21]
  global_load_ushort v41, v9, s[20:21] offset:256
  global_load_dword v38, v8, s[22:23]
  global_load_ushort v42, v9, s[22:23] offset:256
  global_load_dword v39, v8, s[24:25]
  global_load_ushort v43, v9, s[24:25] offset:256
  s_load_dword s67, s[26:27], s66
  s_load_dword s68, s[28:29], s66
  s_load_dword s69, s[38:39], s66
  s_branch R_s
K_g:
  s_getpc_b64 s[10:11]
K_pc:
  s_lshl_b32 s9, s8, 2
  s_add_u32 s9, s9, s3
  s_mul_i32 s9, s9, 384
  s_mov_b64 exec, 7
  v_mov_b32 v3, s11
  v_lshl_add_u32 v2, v0, 7, s9
  v_min_u32 v2, K_last-K_pc, v2
  v_add_co_u32 v2, vcc, s10, v2
  s_nop 1
  v_addc_co_u32 v3, vcc, 0, v3, vcc
  global_load_dword v255, v[2:3], off
  s_mov_b64 exec, -1
  s_branch K_g2
K_l:
  s_and_b32 s57, s8, 7
  s_mul_i32 s57, s57, 3
  s_lshr_b32 s57, s57, 3
  s_lshl_b32 s57, s57, 1
  s_lshr_b32 s70, s8, 3
  s_add_u32 s70, s70, s57
  s_sub_u32 s57, s70, 5
  s_cselect_b32 s70, s70, s57
  v_mov_b32 v10, 1
  v_mov_b32 v11, 1
  v_lshlrev_b32 v9, 3, v0
  ds_write_b64 v9, v[10:11] offset:1024
  v_lshrrev_b32 v1, 3, v0
  v_and_b32 v2, 7, v0
  v_lshrrev_b32 v3, 1, v1
  v_xor_b32 v4, v2, v3
  s_movk_i32 s57, 1280
  v_lshlrev_b32 v4, 4, v4
  v_mad_u32_u24 v4, v1, s57, v4
  s_movk_i32 s57, 9216
  v_xor_b32 v5, 64, v4
  v_add_u32 v5, s57, v5
  s_lshl_b32 s57, s57, 1
  v_add_u32 v6, s57, v4
  v_add_u32 v7, s57, v5
  s_lshr_b32 s56, s2, 1
  s_xor_b32 s56, s56, s2
  s_and_b32 s56, s56, 1
  s_mul_i32 s58, s56, 640
  s_mul_i32 s57, s4, 81920
  s_add_u32 s58, s58, s57
  s_mov_b32 m0, 40960
  s_mov_b32 s47, 40960
  s_mov_b32 s72, 2
  s_mov_b32 s64, s70
  s_mov_b32 s54, 2621440
  s_mov_b32 s55, 0x20000
  s_mov_b32 s79, 0x20000
  s_mov_b32 s78, 0
  s_waitcnt lgkmcnt(0)
  s_mov_b32 s52, s16
  s_and_b32 s53, s17, 0xffff
  s_mov_b64 s[76:77], s[52:53]
  s_call_b64 s[30:31], L_loop
  s_branch R_l
L_loop:
  s_lshl_b32 s11, s70, 7
  s_add_u32 s11, s11, s58
  buffer_load_dwordx4 v4, s[52:55], s11 offen offset:0 lds
  buffer_load_dwordx4 v5, s[52:55], s11 offen offset:1024 lds
  buffer_load_dwordx4 v6, s[52:55], s11 offen offset:2048 lds
  buffer_load_dwordx4 v7, s[52:55], s11 offen offset:3072 lds
  s_add_u32 m0, m0, 4096
  s_add_u32 s11, s11, s47
  buffer_load_dwordx4 v4, s[52:55], s11 offen offset:0 lds
  buffer_load_dwordx4 v5, s[52:55], s11 offen offset:1024 lds
  buffer_load_dwordx4 v6, s[52:55], s11 offen offset:2048 lds
  buffer_load_dwordx4 v7, s[52:55], s11 offen offset:3072 lds
  s_add_u32 m0, m0, 4096
  s_add_u32 s70, s70, 1
  s_cmp_eq_u32 s70, 5
  s_cselect_b32 s70, 0, s70
  s_sub_u32 s72, s72, 1
  s_cbranch_scc0 L_loop
  s_setpc_b64 s[30:31]
K_g2:
  v_mov_b64 v[64:65], 0
  v_mov_b64 v[66:67], 0
  s_xor_b32 s11, s3, 3
  s_or_b32 s11, s11, s8
  s_waitcnt lgkmcnt(0)
  s_mov_b32 s48, s44
  s_and_b32 s49, s45, 0xffff
  s_mov_b32 s50, 16842752
  s_mov_b32 s51, 0x20000
  s_cmp_lg_u32 s11, 0
  s_cbranch_scc1 K_f
  v_lshlrev_b32 v10, 7, v0
  s_lshl_b32 s64, s2, 13
  s_add_u32 s64, s64, 16777216
  buffer_store_dword v64, v10, s[48:51], s64 offen sc1
K_f:
  s_mul_i32 s63, s3, 4800
  v_lshl_add_u32 v16, v0, 4, s63
  ds_write_b128 v16, v[64:67] offset:15360
  ds_write_b128 v16, v[64:67] offset:16384
  ds_write_b128 v16, v[64:67] offset:17408
  ds_write_b128 v16, v[64:67] offset:18432
  ds_write_b128 v16, v[64:67] offset:19136
  s_mul_i32 s63, s3, 448
  s_add_u32 s63, s63, 39104
  s_min_u32 s64, s3, 2
  s_mul_i32 s64, s64, 4608
  s_add_u32 s64, s64, 1024
  v_lshl_add_u32 v16, v0, 4, s63
  v_lshl_add_u32 v17, v0, 4, s64
  v_cmp_gt_u32 vcc, 32, v0
  s_mov_b32 exec_lo, 0xfffffff0
  s_nop 0
  v_cndmask_b32 v16, v17, v16, vcc
  ds_write_b128 v16, v[64:67]
  s_mov_b64 exec, -1
  s_branch R_g
K_end:
  s_endpgm
L_body2:
  s_add_u32 m0, s59, 0
  s_add_u32 s11, s58, s64
  buffer_load_dwordx4 v44, s[52:55], s11 offen offset:0 sc1 lds
  buffer_load_dwordx4 v45, s[52:55], s11 offen offset:1024 sc1 lds
  buffer_load_dwordx4 v46, s[52:55], s11 offen offset:2048 sc1 lds
  buffer_load_dwordx4 v47, s[52:55], s11 offen offset:3072 sc1 lds
  s_add_u32 m0, m0, 4096
  s_add_u32 s11, s11, s47
  buffer_load_dwordx4 v44, s[52:55], s11 offen offset:0 sc1 lds
  buffer_load_dwordx4 v45, s[52:55], s11 offen offset:1024 sc1 lds
  buffer_load_dwordx4 v46, s[52:55], s11 offen offset:2048 sc1 lds
  buffer_load_dwordx4 v47, s[52:55], s11 offen offset:3072 sc1 lds
  s_add_u32 m0, s59, 8192
  s_add_u32 s11, s58, s65
  buffer_load_dwordx4 v44, s[52:55], s11 offen offset:0 sc1 lds
  buffer_load_dwordx4 v45, s[52:55], s11 offen offset:1024 sc1 lds
  buffer_load_dwordx4 v46, s[52:55], s11 offen offset:2048 sc1 lds
  buffer_load_dwordx4 v47, s[52:55], s11 offen offset:3072 sc1 lds
  s_add_u32 m0, m0, 4096
  s_add_u32 s11, s11, s47
  buffer_load_dwordx4 v44, s[52:55], s11 offen offset:0 sc1 lds
  buffer_load_dwordx4 v45, s[52:55], s11 offen offset:1024 sc1 lds
  buffer_load_dwordx4 v46, s[52:55], s11 offen offset:2048 sc1 lds
  buffer_load_dwordx4 v47, s[52:55], s11 offen offset:3072 sc1 lds
  s_add_u32 m0, s59, 16384
  s_add_u32 s11, s58, s66
  buffer_load_dwordx4 v44, s[52:55], s11 offen offset:0 sc1 lds
  buffer_load_dwordx4 v45, s[52:55], s11 offen offset:1024 sc1 lds
  buffer_load_dwordx4 v46, s[52:55], s11 offen offset:2048 sc1 lds
  buffer_load_dwordx4 v47, s[52:55], s11 offen offset:3072 sc1 lds
  s_add_u32 m0, m0, 4096
  s_add_u32 s11, s11, s47
  buffer_load_dwordx4 v44, s[52:55], s11 offen offset:0 sc1 lds
  buffer_load_dwordx4 v45, s[52:55], s11 offen offset:1024 sc1 lds
  buffer_load_dwordx4 v46, s[52:55], s11 offen offset:2048 sc1 lds
  buffer_load_dwordx4 v47, s[52:55], s11 offen offset:3072 sc1 lds
  s_add_u32 m0, s46, 320
  s_mov_b64 exec, 1
  buffer_load_dword off, s[76:79], 0 lds
  s_mov_b64 exec, -1
  s_add_u32 m0, s59, 24576
  s_add_u32 s11, s58, s67
  buffer_load_dwordx4 v44, s[52:55], s11 offen offset:0 sc1 lds
  buffer_load_dwordx4 v45, s[52:55], s11 offen offset:1024 sc1 lds
  buffer_load_dwordx4 v46, s[52:55], s11 offen offset:2048 sc1 lds
  buffer_load_dwordx4 v47, s[52:55], s11 offen offset:3072 sc1 lds
  s_add_u32 m0, m0, 4096
  s_add_u32 s11, s11, s47
  buffer_load_dwordx4 v44, s[52:55], s11 offen offset:0 sc1 lds
  buffer_load_dwordx4 v45, s[52:55], s11 offen offset:1024 sc1 lds
  buffer_load_dwordx4 v46, s[52:55], s11 offen offset:2048 sc1 lds
  buffer_load_dwordx4 v47, s[52:55], s11 offen offset:3072 sc1 lds
  s_add_u32 m0, s59, 32768
  s_add_u32 s11, s58, s68
  buffer_load_dwordx4 v44, s[52:55], s11 offen offset:0 sc1 lds
  buffer_load_dwordx4 v45, s[52:55], s11 offen offset:1024 sc1 lds
  buffer_load_dwordx4 v46, s[52:55], s11 offen offset:2048 sc1 lds
  buffer_load_dwordx4 v47, s[52:55], s11 offen offset:3072 sc1 lds
  s_add_u32 m0, m0, 4096
  s_add_u32 s11, s11, s47
  buffer_load_dwordx4 v44, s[52:55], s11 offen offset:0 sc1 lds
  buffer_load_dwordx4 v45, s[52:55], s11 offen offset:1024 sc1 lds
  buffer_load_dwordx4 v46, s[52:55], s11 offen offset:2048 sc1 lds
  buffer_load_dwordx4 v47, s[52:55], s11 offen offset:3072 sc1 lds
  s_add_u32 m0, s46, 0
  s_mov_b64 exec, 1
  buffer_load_dword off, s[76:79], 0 lds
  s_mov_b64 exec, -1
  s_add_u32 s46, s46, 4
  s_add_u32 s59, s59, 40960
  s_cmp_eq_u32 s59, 163840
  s_cselect_b32 s59, 40960, s59
  s_setpc_b64 s[30:31]
.p2align 6
R_l:
  s_mov_b32 s12, 0x400000
  s_mul_i32 s9, s4, 43
  s_lshr_b32 s9, s9, 7
  s_mul_i32 s10, s9, 3
  s_sub_u32 s6, s4, s10
  s_lshr_b32 s6, s4, 3
  s_cmp_eq_u32 s6, 3
  s_cselect_b32 s6, 2, s6
  s_mov_b32 s48, s44
  s_and_b32 s49, s45, 0xffff
  s_mov_b32 s50, 16842752
  s_mov_b32 s51, 0x20000
  s_mov_b32 s24, s36
  s_and_b32 s25, s37, 0xffff
  s_mov_b32 s26, 1966080
  s_mov_b32 s27, 0x20000
  v_and_b32 v3, 1, v3
  v_lshlrev_b32 v3, 2, v3
  v_xor_b32 v3, v2, v3
  v_mul_u32_u24 v44, 3072, v1
  v_lshl_add_u32 v44, v3, 4, v44
  v_add_u32 v45, 23552, v44
  v_add_u32 v46, 47104, v44
  v_add_u32 v47, 70656, v44
  v_and_b32 v3, 3, v0
  v_lshlrev_b32 v13, 2, v3
  v_min_u32 v3, 2, v3
  v_lshlrev_b32 v14, 2, v3
  v_lshlrev_b32 v36, 4, v2
  v_mul_u32_u24 v37, 1280, v1
  v_add_u32 v36, v36, v37
  v_add_u32 v37, 9216, v36
  v_add_u32 v38, 18432, v36
  v_add_u32 v39, 27648, v36
  s_add_u32 s65, s64, 1
  s_cmp_eq_u32 s65, 5
  s_cselect_b32 s65, 0, s65
  s_add_u32 s66, s65, 1
  s_cmp_eq_u32 s66, 5
  s_cselect_b32 s66, 0, s66
  s_add_u32 s67, s66, 1
  s_cmp_eq_u32 s67, 5
  s_cselect_b32 s67, 0, s67
  s_add_u32 s68, s67, 1
  s_cmp_eq_u32 s68, 5
  s_cselect_b32 s68, 0, s68
  s_mul_i32 s64, s64, 196608
  s_mul_i32 s65, s65, 196608
  s_mul_i32 s66, s66, 196608
  s_mul_i32 s67, s67, 196608
  s_mul_i32 s68, s68, 196608
  s_barrier
  s_mov_b32 s72, 1
  s_call_b64 s[30:31], L_loop
  s_mov_b32 m0, 1024
  s_mov_b64 exec, 1
  buffer_load_dword off, s[76:79], 0 lds
  s_mov_b64 exec, -1
  s_xor_b32 s58, s56, 1
  s_mul_i32 s58, s58, 640
  s_add_u32 s58, s58, s57
  s_mov_b32 s72, 4
  s_mov_b32 m0, 81920
  s_call_b64 s[30:31], L_loop
  s_mov_b32 m0, 1028
  s_mov_b64 exec, 1
  buffer_load_dword off, s[76:79], 0 lds
  s_mov_b64 exec, -1
  s_mov_b32 s52, s32
  s_and_b32 s53, s33, 0xffff
  s_mov_b32 s54, 1966080
  s_mov_b32 s55, 0x20000
  s_mul_i32 s57, s5, 384
  s_mov_b32 s47, 98304
  s_mov_b32 s59, 122880
  s_movk_i32 s46, 1032
  s_add_u32 s58, s6, 0
  s_cmp_ge_u32 s58, 3
  s_cselect_b32 s63, 3, 0
  s_sub_u32 s58, s58, s63
  s_lshl_b32 s58, s58, 7
  s_add_u32 s58, s58, s57
  s_xor_b32 s63, s56, 0
  s_mul_i32 s63, s63, 983040
  s_add_u32 s58, s58, s63
  s_lshl_b32 s73, s5, 5
  s_add_u32 s73, s73, s4
  s_mul_i32 s74, s73, 171
  s_lshr_b32 s74, s74, 12
  s_mul_i32 s63, s74, 24
  s_sub_u32 s73, s73, s63
  s_min_u32 s71, s74, 9
  s_lshl_b32 s71, s71, 7
  s_mul_i32 s70, s73, 81920
  s_add_u32 s70, s70, s71
  s_mov_b32 m0, 2048
  s_nop 0
  buffer_load_dwordx4 v36, s[24:27], s70 offen offset:0 lds
  buffer_load_dwordx4 v37, s[24:27], s70 offen offset:1024 lds
  buffer_load_dwordx4 v38, s[24:27], s70 offen offset:2048 lds
  buffer_load_dwordx4 v39, s[24:27], s70 offen offset:3072 lds
  s_add_u32 s70, s70, 40960
  s_mov_b32 m0, 6656
  s_nop 0
  buffer_load_dwordx4 v36, s[24:27], s70 offen offset:0 lds
  buffer_load_dwordx4 v37, s[24:27], s70 offen offset:1024 lds
  buffer_load_dwordx4 v38, s[24:27], s70 offen offset:2048 lds
  buffer_load_dwordx4 v39, s[24:27], s70 offen offset:3072 lds
  s_add_u32 s70, s70, 40960
  s_call_b64 s[30:31], L_body2
  s_add_u32 s58, s6, 0
  s_cmp_ge_u32 s58, 3
  s_cselect_b32 s63, 3, 0
  s_sub_u32 s58, s58, s63
  s_lshl_b32 s58, s58, 7
  s_add_u32 s58, s58, s57
  s_xor_b32 s63, s56, 1
  s_mul_i32 s63, s63, 983040
  s_add_u32 s58, s58, s63
  s_bitcmp1_b32 s2, 1
  s_cbranch_scc1 NS_9
SP_10:
  ds_read_b32 v15, v14 offset:1264
  s_waitcnt lgkmcnt(0)
  v_cmp_ne_u32 vcc, 0, v15
  s_cbranch_vccz SO_11
  s_sleep 2
  s_sub_u32 s12, s12, 1
  s_cbranch_scc0 SP_10
  s_mov_b32 s12, 0
SO_11:
NS_9:
SP_12:
  ds_read_b32 v15, v13 offset:1088
  s_waitcnt lgkmcnt(0)
  v_cmp_ne_u32 vcc, 0, v15
  s_cbranch_vccz SO_13
  s_sleep 2
  s_sub_u32 s12, s12, 1
  s_cbranch_scc0 SP_12
  s_mov_b32 s12, 0
SO_13:
  s_call_b64 s[30:31], L_body2
  s_setprio 0
  s_add_u32 s58, s6, 1
  s_cmp_ge_u32 s58, 3
  s_cselect_b32 s63, 3, 0
  s_sub_u32 s58, s58, s63
  s_lshl_b32 s58, s58, 7
  s_add_u32 s58, s58, s57
  s_xor_b32 s63, s56, 0
  s_mul_i32 s63, s63, 983040
  s_add_u32 s58, s58, s63
SP_14:
  ds_read_b32 v15, v14 offset:1264
  s_waitcnt lgkmcnt(0)
  v_cmp_ne_u32 vcc, 0, v15
  s_cbranch_vccz SO_15
  s_sleep 2
  s_sub_u32 s12, s12, 1
  s_cbranch_scc0 SP_14
  s_mov_b32 s12, 0
SO_15:
SP_16:
  ds_read_b32 v15, v13 offset:1104
  s_waitcnt lgkmcnt(0)
  v_cmp_ne_u32 vcc, 0, v15
  s_cbranch_vccz SO_17
  s_sleep 2
  s_sub_u32 s12, s12, 1
  s_cbranch_scc0 SP_16
  s_mov_b32 s12, 0
SO_17:
  s_call_b64 s[30:31], L_body2
  v_lshrrev_b32 v40, 5, v0
  v_lshlrev_b32 v40, 4, v40
  v_bfe_u32 v41, v0, 2, 3
  v_add_u32 v40, v40, v41
  v_lshlrev_b32 v40, 7, v40
  v_and_b32 v41, 3, v0
  v_lshl_add_u32 v40, v41, 3, v40
  v_lshlrev_b32 v42, 4, v0
  v_add_u32 v43, 5120, v42
  s_mul_i32 s63, s73, 43
  s_lshr_b32 s63, s63, 7
  s_mul_i32 s71, s63, 3
  s_sub_u32 s73, s73, s71
  s_lshl_b32 s73, s73, 3
  s_add_u32 s73, s73, s63
  s_mul_i32 s73, s73, 10240
  s_add_u32 s73, s73, 6291456
  s_cmp_ge_u32 s74, 10
  s_cselect_b32 s73, 16842752, s73
  s_lshl_b32 s34, s74, 2
  s_add_u32 s34, s34, 0
  s_mul_i32 s63, s34, 52
  s_lshr_b32 s63, s63, 8
  s_mul_i32 s71, s63, 5
  s_sub_u32 s34, s34, s71
  s_and_b32 s71, s63, 1
  s_sub_u32 s34, s34, s71
  s_cselect_b32 s34, 4, s34
  s_mul_i32 s63, s63, 240
  s_add_u32 s34, s34, s63
  s_lshl_b32 s34, s34, 10
  s_add_u32 s34, s34, s73
  s_lshl_b32 s35, s74, 2
  s_add_u32 s35, s35, 1
  s_mul_i32 s63, s35, 52
  s_lshr_b32 s63, s63, 8
  s_mul_i32 s71, s63, 5
  s_sub_u32 s35, s35, s71
  s_and_b32 s71, s63, 1
  s_sub_u32 s35, s35, s71
  s_cselect_b32 s35, 4, s35
  s_mul_i32 s63, s63, 240
  s_add_u32 s35, s35, s63
  s_lshl_b32 s35, s35, 10
  s_add_u32 s35, s35, s73
  s_lshl_b32 s38, s74, 2
  s_add_u32 s38, s38, 2
  s_mul_i32 s63, s38, 52
  s_lshr_b32 s63, s63, 8
  s_mul_i32 s71, s63, 5
  s_sub_u32 s38, s38, s71
  s_and_b32 s71, s63, 1
  s_sub_u32 s38, s38, s71
  s_cselect_b32 s38, 4, s38
  s_mul_i32 s63, s63, 240
  s_add_u32 s38, s38, s63
  s_lshl_b32 s38, s38, 10
  s_add_u32 s38, s38, s73
  s_lshl_b32 s39, s74, 2
  s_add_u32 s39, s39, 3
  s_mul_i32 s63, s39, 52
  s_lshr_b32 s63, s63, 8
  s_mul_i32 s71, s63, 5
  s_sub_u32 s39, s39, s71
  s_and_b32 s71, s63, 1
  s_sub_u32 s39, s39, s71
  s_cselect_b32 s39, 4, s39
  s_mul_i32 s63, s63, 240
  s_add_u32 s39, s39, s63
  s_lshl_b32 s39, s39, 10
  s_add_u32 s39, s39, s73
  s_lshl_b32 s74, s74, 10
  s_add_u32 s74, s74, 16818176
  s_mul_i32 s60, s5, 5
  s_lshr_b32 s60, s60, 2
  s_lshl_b32 s60, s60, 10
  s_lshr_b32 s61, s4, 2
  s_lshl_b32 s61, s61, 7
  s_add_u32 s60, s60, s61
  s_add_u32 s60, s60, 16818176
  s_mul_i32 s75, s5, 245760
  s_add_u32 s75, s75, 6291456
  s_waitcnt vmcnt(42)
  ds_read_b64_tr_b16 v[48:49], v40 offset:2048
  ds_read_b64_tr_b16 v[50:51], v40 offset:3072
  ds_read_b64_tr_b16 v[52:53], v40 offset:6656
  ds_read_b64_tr_b16 v[54:55], v40 offset:7680
  ds_read_b64_tr_b16 v[56:57], v40 offset:2080
  ds_read_b64_tr_b16 v[58:59], v40 offset:3104
  ds_read_b64_tr_b16 v[60:61], v40 offset:6688
  ds_read_b64_tr_b16 v[62:63], v40 offset:7712
  ds_read_b64_tr_b16 v[64:65], v40 offset:2112
  ds_read_b64_tr_b16 v[66:67], v40 offset:3136
  ds_read_b64_tr_b16 v[68:69], v40 offset:6720
  ds_read_b64_tr_b16 v[70:71], v40 offset:7744
  ds_read_b64_tr_b16 v[72:73], v40 offset:2144
  ds_read_b64_tr_b16 v[74:75], v40 offset:3168
  ds_read_b64_tr_b16 v[76:77], v40 offset:6752
  ds_read_b64_tr_b16 v[78:79], v40 offset:7776
  s_waitcnt lgkmcnt(14)
  buffer_store_dwordx4 v[48:51], v42, s[48:51], s34 offen sc1
  s_waitcnt lgkmcnt(12)
  buffer_store_dwordx4 v[52:55], v43, s[48:51], s34 offen sc1
  s_waitcnt lgkmcnt(10)
  buffer_store_dwordx4 v[56:59], v42, s[48:51], s35 offen sc1
  s_waitcnt lgkmcnt(8)
  buffer_store_dwordx4 v[60:63], v43, s[48:51], s35 offen sc1
  s_waitcnt lgkmcnt(6)
  buffer_store_dwordx4 v[64:67], v42, s[48:51], s38 offen sc1
  s_waitcnt lgkmcnt(4)
  buffer_store_dwordx4 v[68:71], v43, s[48:51], s38 offen sc1
  s_waitcnt lgkmcnt(2)
  buffer_store_dwordx4 v[72:75], v42, s[48:51], s39 offen sc1
  s_waitcnt lgkmcnt(0)
  buffer_store_dwordx4 v[76:79], v43, s[48:51], s39 offen sc1
  v_and_b32 v17, 7, v0
  v_lshlrev_b32 v17, 2, v17
  global_load_dword v16, v17, s[42:43] sc1
  s_add_u32 s58, s6, 1
  s_cmp_ge_u32 s58, 3
  s_cselect_b32 s63, 3, 0
  s_sub_u32 s58, s58, s63
  s_lshl_b32 s58, s58, 7
  s_add_u32 s58, s58, s57
  s_xor_b32 s63, s56, 1
  s_mul_i32 s63, s63, 983040
  s_add_u32 s58, s58, s63
SP_18:
  ds_read_b32 v15, v13 offset:1120
  s_waitcnt lgkmcnt(0)
  v_cmp_ne_u32 vcc, 0, v15
  s_cbranch_vccz SO_19
  s_sleep 2
  s_sub_u32 s12, s12, 1
  s_cbranch_scc0 SP_18
  s_mov_b32 s12, 0
SO_19:
  s_call_b64 s[30:31], L_body2
  s_waitcnt vmcnt(42)
  v_cmp_eq_u32 vcc, 0, v16
  s_cbranch_vccnz SL_1
BK_2:
  v_mov_b32 v16, 1
  v_lshlrev_b32 v17, 7, v0
  s_mov_b64 exec, 255
  buffer_atomic_add v16, v17, s[48:51], s74 offen sc1
  s_mov_b64 exec, -1
  s_add_u32 s58, s6, 2
  s_cmp_ge_u32 s58, 3
  s_cselect_b32 s63, 3, 0
  s_sub_u32 s58, s58, s63
  s_lshl_b32 s58, s58, 7
  s_add_u32 s58, s58, s57
  s_xor_b32 s63, s56, 0
  s_mul_i32 s63, s63, 983040
  s_add_u32 s58, s58, s63
SP_20:
  ds_read_b32 v15, v13 offset:1136
  s_waitcnt lgkmcnt(0)
  v_cmp_ne_u32 vcc, 0, v15
  s_cbranch_vccz SO_21
  s_sleep 2
  s_sub_u32 s12, s12, 1
  s_cbranch_scc0 SP_20
  s_mov_b32 s12, 0
SO_21:
  s_call_b64 s[30:31], L_body2
  s_add_u32 s58, s6, 2
  s_cmp_ge_u32 s58, 3
  s_cselect_b32 s63, 3, 0
  s_sub_u32 s58, s58, s63
  s_lshl_b32 s58, s58, 7
  s_add_u32 s58, s58, s57
  s_xor_b32 s63, s56, 1
  s_mul_i32 s63, s63, 983040
  s_add_u32 s58, s58, s63
SP_22:
  ds_read_b32 v15, v13 offset:1152
  s_waitcnt lgkmcnt(0)
  v_cmp_ne_u32 vcc, 0, v15
  s_cbranch_vccz SO_23
  s_sleep 2
  s_sub_u32 s12, s12, 1
  s_cbranch_scc0 SP_22
  s_mov_b32 s12, 0
SO_23:
  v_lshlrev_b32 v17, 10, v0
  v_mov_b32 v16, 0
  s_mov_b64 exec, 3
  buffer_atomic_add v16, v17, s[48:51], s60 offen sc0 sc1
  s_mov_b64 exec, -1
  s_call_b64 s[30:31], L_body2
  s_mov_b64 exec, 3
  s_waitcnt vmcnt(42)
  v_cmp_gt_u32 vcc, 24, v16
  s_mov_b64 exec, -1
  s_cbranch_vccnz SL_5
BK_6:
  s_mov_b32 s52, s44
  s_and_b32 s53, s45, 0xffff
  s_mov_b32 s54, 16842752
  s_mov_b32 s55, 0x20000
  v_lshlrev_b32 v44, 4, v0
  v_mov_b32 v45, v44
  v_mov_b32 v46, v44
  v_mov_b32 v47, v44
  s_mov_b32 s47, 4096
  s_mov_b32 s64, 0
  s_mov_b32 s65, 8192
  s_mov_b32 s66, 16384
  s_mov_b32 s67, 24576
  s_mov_b32 s68, 32768
  s_mov_b32 s24, s16
  s_and_b32 s25, s17, 0xffff
  s_mov_b32 s26, 2621440
  s_mov_b32 s27, 0x20000
  s_add_u32 s58, s6, 0
  s_cmp_ge_u32 s58, 3
  s_cselect_b32 s63, 3, 0
  s_sub_u32 s58, s58, s63
  s_mul_i32 s58, s58, 81920
  s_add_u32 s58, s58, s75
  s_and_b32 s63, s5, 1
  s_xor_b32 s63, s63, 0
  s_mul_i32 s63, s63, 40960
  s_add_u32 s58, s58, s63
SP_28:
  ds_read_b32 v15, v13 offset:1168
  s_waitcnt lgkmcnt(0)
  v_cmp_ne_u32 vcc, 0, v15
  s_cbranch_vccz SO_29
  s_sleep 2
  s_sub_u32 s12, s12, 1
  s_cbranch_scc0 SP_28
  s_mov_b32 s12, 0
SO_29:
  s_call_b64 s[30:31], L_body2
  s_add_u32 s58, s6, 0
  s_cmp_ge_u32 s58, 3
  s_cselect_b32 s63, 3, 0
  s_sub_u32 s58, s58, s63
  s_mul_i32 s58, s58, 81920
  s_add_u32 s58, s58, s75
  s_and_b32 s63, s5, 1
  s_xor_b32 s63, s63, 1
  s_mul_i32 s63, s63, 40960
  s_add_u32 s58, s58, s63
SP_30:
  ds_read_b32 v15, v13 offset:1184
  s_waitcnt lgkmcnt(0)
  v_cmp_ne_u32 vcc, 0, v15
  s_cbranch_vccz SO_31
  s_sleep 2
  s_sub_u32 s12, s12, 1
  s_cbranch_scc0 SP_30
  s_mov_b32 s12, 0
SO_31:
  s_call_b64 s[30:31], L_body2
  s_add_u32 s58, s6, 1
  s_cmp_ge_u32 s58, 3
  s_cselect_b32 s63, 3, 0
  s_sub_u32 s58, s58, s63
  s_mul_i32 s58, s58, 81920
  s_add_u32 s58, s58, s75
  s_and_b32 s63, s5, 1
  s_xor_b32 s63, s63, 0
  s_mul_i32 s63, s63, 40960
  s_add_u32 s58, s58, s63
SP_32:
  ds_read_b32 v15, v13 offset:1200
  s_waitcnt lgkmcnt(0)
  v_cmp_ne_u32 vcc, 0, v15
  s_cbranch_vccz SO_33
  s_sleep 2
  s_sub_u32 s12, s12, 1
  s_cbranch_scc0 SP_32
  s_mov_b32 s12, 0
SO_33:
  s_call_b64 s[30:31], L_body2
  v_add_u32 v9, 0, v0
  v_mul_u32_u24 v10, 6554, v9
  v_lshrrev_b32 v10, 16, v10
  v_mul_u32_u24 v10, 1120, v10
  v_lshl_add_u32 v20, v9, 4, v10
  v_add_u32 v9, 64, v0
  v_mul_u32_u24 v10, 6554, v9
  v_lshrrev_b32 v10, 16, v10
  v_mul_u32_u24 v10, 1120, v10
  v_lshl_add_u32 v21, v9, 4, v10
  v_add_u32 v9, 128, v0
  v_mul_u32_u24 v10, 6554, v9
  v_lshrrev_b32 v10, 16, v10
  v_mul_u32_u24 v10, 1120, v10
  v_lshl_add_u32 v22, v9, 4, v10
  v_add_u32 v9, 192, v0
  v_mul_u32_u24 v10, 6554, v9
  v_lshrrev_b32 v10, 16, v10
  v_mul_u32_u24 v10, 1120, v10
  v_lshl_add_u32 v23, v9, 4, v10
  v_add_u32 v9, 256, v0
  v_mul_u32_u24 v10, 6554, v9
  v_lshrrev_b32 v10, 16, v10
  v_mul_u32_u24 v10, 1120, v10
  v_lshl_add_u32 v24, v9, 4, v10
  v_add_u32 v9, 320, v0
  v_mul_u32_u24 v10, 6554, v9
  v_lshrrev_b32 v10, 16, v10
  v_mul_u32_u24 v10, 1120, v10
  v_lshl_add_u32 v25, v9, 4, v10
  v_add_u32 v9, 384, v0
  v_mul_u32_u24 v10, 6554, v9
  v_lshrrev_b32 v10, 16, v10
  v_mul_u32_u24 v10, 1120, v10
  v_lshl_add_u32 v26, v9, 4, v10
  v_add_u32 v9, 448, v0
  v_mul_u32_u24 v10, 6554, v9
  v_lshrrev_b32 v10, 16, v10
  v_mul_u32_u24 v10, 1120, v10
  v_lshl_add_u32 v27, v9, 4, v10
  v_add_u32 v9, 512, v0
  v_mul_u32_u24 v10, 6554, v9
  v_lshrrev_b32 v10, 16, v10
  v_mul_u32_u24 v10, 1120, v10
  v_lshl_add_u32 v28, v9, 4, v10
  v_add_u32 v9, 576, v0
  v_mul_u32_u24 v10, 6554, v9
  v_lshrrev_b32 v10, 16, v10
  v_mul_u32_u24 v10, 1120, v10
  v_lshl_add_u32 v29, v9, 4, v10
  v_lshlrev_b32 v3, 4, v2
  v_mul_u32_u24 v32, 4224, v1
  v_add_u32 v32, v32, v3
  v_add_u32 v33, 32768, v32
  v_add_u32 v34, 65536, v32
  v_add_u32 v35, 98304, v32
  v_lshrrev_b32 v9, 1, v0
  v_mov_b32 v10, 0x2000
  v_lshrrev_b32 v9, v9, v10
  s_mul_i32 s69, s5, 3072
  s_add_u32 s69, s69, s61
  s_add_u32 s69, s69, 16793600
  s_mul_i32 s61, s5, 337920
  s_lshl_b32 s62, s4, 7
  s_add_u32 s61, s61, s62
  s_add_u32 s61, s61, 11534336
  s_mul_i32 s62, s4, 81920
  s_mul_i32 s63, s5, 160
  s_add_u32 s62, s62, s63
SP_34:
  ds_read_b32 v15, v14 offset:1280
  s_waitcnt lgkmcnt(0)
  v_cmp_ne_u32 vcc, 0, v15
  s_cbranch_vccz SO_35
  s_sleep 2
  s_sub_u32 s12, s12, 1
  s_cbranch_scc0 SP_34
  s_mov_b32 s12, 0
SO_35:
SP_36:
  ds_read_b32 v15, v14 offset:1296
  s_waitcnt lgkmcnt(0)
  v_cmp_ne_u32 vcc, 0, v15
  s_cbranch_vccz SO_37
  s_sleep 2
  s_sub_u32 s12, s12, 1
  s_cbranch_scc0 SP_36
  s_mov_b32 s12, 0
SO_37:
  s_mov_b32 m0, 15360
  s_nop 0
  buffer_load_dwordx4 v20, s[24:27], s62 offen lds
  s_mov_b32 m0, 16384
  s_nop 0
  buffer_load_dwordx4 v21, s[24:27], s62 offen lds
  s_mov_b32 m0, 17408
  s_nop 0
  buffer_load_dwordx4 v22, s[24:27], s62 offen lds
  s_mov_b32 m0, 18432
  s_nop 0
  buffer_load_dwordx4 v23, s[24:27], s62 offen lds
  s_mov_b32 m0, 19456
  s_nop 0
  buffer_load_dwordx4 v24, s[24:27], s62 offen lds
  s_mov_b32 m0, 20480
  s_nop 0
  buffer_load_dwordx4 v25, s[24:27], s62 offen lds
  s_mov_b32 m0, 21504
  s_nop 0
  buffer_load_dwordx4 v26, s[24:27], s62 offen lds
  s_mov_b32 m0, 22528
  s_nop 0
  buffer_load_dwordx4 v27, s[24:27], s62 offen lds
  s_mov_b32 m0, 23552
  s_nop 0
  buffer_load_dwordx4 v28, s[24:27], s62 offen lds
  s_mov_b32 m0, 24576
  s_nop 0
  buffer_load_dwordx4 v29, s[24:27], s62 offen lds
  s_add_u32 s58, s6, 2
  s_cmp_ge_u32 s58, 3
  s_cselect_b32 s63, 3, 0
  s_sub_u32 s58, s58, s63
  s_mul_i32 s58, s58, 81920
  s_add_u32 s58, s58, s75
  s_and_b32 s63, s5, 1
  s_xor_b32 s63, s63, 1
  s_mul_i32 s63, s63, 40960
  s_add_u32 s58, s58, s63
  s_mov_b32 m0, 25600
  s_add_u32 s11, s58, 25600
  buffer_load_dwordx4 v44, s[52:55], s11 offen offset:0 sc1 lds
  buffer_load_dwordx4 v44, s[52:55], s11 offen offset:1024 sc1 lds
  buffer_load_dwordx4 v44, s[52:55], s11 offen offset:2048 sc1 lds
  buffer_load_dwordx4 v44, s[52:55], s11 offen offset:3072 sc1 lds
  s_mov_b32 m0, 29696
  s_add_u32 s11, s58, 29696
  buffer_load_dwordx4 v44, s[52:55], s11 offen offset:0 sc1 lds
  buffer_load_dwordx4 v44, s[52:55], s11 offen offset:1024 sc1 lds
  buffer_load_dwordx4 v44, s[52:55], s11 offen offset:2048 sc1 lds
  buffer_load_dwordx4 v44, s[52:55], s11 offen offset:3072 sc1 lds
  s_mov_b32 m0, 33792
  s_add_u32 s11, s58, 33792
  buffer_load_dwordx4 v44, s[52:55], s11 offen offset:0 sc1 lds
  buffer_load_dwordx4 v44, s[52:55], s11 offen offset:1024 sc1 lds
  buffer_load_dwordx4 v44, s[52:55], s11 offen offset:2048 sc1 lds
  buffer_load_dwordx4 v44, s[52:55], s11 offen offset:3072 sc1 lds
  s_mov_b32 m0, 37888
  s_add_u32 s11, s58, 37888
  buffer_load_dwordx4 v44, s[52:55], s11 offen offset:0 sc1 lds
  buffer_load_dwordx4 v44, s[52:55], s11 offen offset:1024 sc1 lds
  buffer_load_dwordx4 v44, s[52:55], s11 offen offset:2048 sc1 lds
  s_add_u32 s58, s6, 1
  s_cmp_ge_u32 s58, 3
  s_cselect_b32 s63, 3, 0
  s_sub_u32 s58, s58, s63
  s_mul_i32 s58, s58, 81920
  s_add_u32 s58, s58, s75
  s_and_b32 s63, s5, 1
  s_xor_b32 s63, s63, 1
  s_mul_i32 s63, s63, 40960
  s_add_u32 s58, s58, s63
SP_38:
  ds_read_b32 v15, v13 offset:1216
  s_waitcnt lgkmcnt(0)
  v_cmp_ne_u32 vcc, 0, v15
  s_cbranch_vccz SO_39
  s_sleep 2
  s_sub_u32 s12, s12, 1
  s_cbranch_scc0 SP_38
  s_mov_b32 s12, 0
SO_39:
  s_call_b64 s[30:31], L_body2
  s_add_u32 s58, s6, 2
  s_cmp_ge_u32 s58, 3
  s_cselect_b32 s63, 3, 0
  s_sub_u32 s58, s58, s63
  s_mul_i32 s58, s58, 81920
  s_add_u32 s58, s58, s75
  s_and_b32 s63, s5, 1
  s_xor_b32 s63, s63, 0
  s_mul_i32 s63, s63, 40960
  s_add_u32 s58, s58, s63
SP_40:
  ds_read_b32 v15, v13 offset:1232
  s_waitcnt lgkmcnt(0)
  v_cmp_ne_u32 vcc, 0, v15
  s_cbranch_vccz SO_41
  s_sleep 2
  s_sub_u32 s12, s12, 1
  s_cbranch_scc0 SP_40
  s_mov_b32 s12, 0
SO_41:
  s_call_b64 s[30:31], L_body2
  s_add_u32 s58, s6, 2
  s_cmp_ge_u32 s58, 3
  s_cselect_b32 s63, 3, 0
  s_sub_u32 s58, s58, s63
  s_mul_i32 s58, s58, 81920
  s_add_u32 s58, s58, s75
  s_and_b32 s63, s5, 1
  s_xor_b32 s63, s63, 1
  s_mul_i32 s63, s63, 40960
  s_add_u32 s58, s58, s63
SP_42:
  ds_read_b32 v15, v13 offset:1248
  s_waitcnt lgkmcnt(0)
  v_cmp_ne_u32 vcc, 0, v15
  s_cbranch_vccz SO_43
  s_sleep 2
  s_sub_u32 s12, s12, 1
  s_cbranch_scc0 SP_42
  s_mov_b32 s12, 0
SO_43:
  v_lshlrev_b32 v17, 10, v0
  v_mov_b32 v16, 0
  s_mov_b64 exec, 7
  buffer_atomic_add v16, v17, s[48:51], s69 offen sc0 sc1
  s_mov_b64 exec, -1
  s_mov_b32 m0, 81920
  s_add_u32 s11, s58, 0
  buffer_load_dwordx4 v44, s[52:55], s11 offen offset:0 sc1 lds
  buffer_load_dwordx4 v44, s[52:55], s11 offen offset:1024 sc1 lds
  buffer_load_dwordx4 v44, s[52:55], s11 offen offset:2048 sc1 lds
  buffer_load_dwordx4 v44, s[52:55], s11 offen offset:3072 sc1 lds
  s_mov_b32 m0, 86016
  s_add_u32 s11, s58, 4096
  buffer_load_dwordx4 v44, s[52:55], s11 offen offset:0 sc1 lds
  buffer_load_dwordx4 v44, s[52:55], s11 offen offset:1024 sc1 lds
  buffer_load_dwordx4 v44, s[52:55], s11 offen offset:2048 sc1 lds
  buffer_load_dwordx4 v44, s[52:55], s11 offen offset:3072 sc1 lds
  s_mov_b32 m0, 90112
  s_add_u32 s11, s58, 8192
  buffer_load_dwordx4 v44, s[52:55], s11 offen offset:0 sc1 lds
  buffer_load_dwordx4 v44, s[52:55], s11 offen offset:1024 sc1 lds
  s_add_u32 m0, s46, 320
  s_mov_b64 exec, 1
  buffer_load_dword off, s[76:79], 0 lds
  s_mov_b64 exec, -1
  s_mov_b32 m0, 92160
  s_add_u32 s11, s58, 10240
  buffer_load_dwordx4 v44, s[52:55], s11 offen offset:0 sc1 lds
  buffer_load_dwordx4 v44, s[52:55], s11 offen offset:1024 sc1 lds
  buffer_load_dwordx4 v44, s[52:55], s11 offen offset:2048 sc1 lds
  buffer_load_dwordx4 v44, s[52:55], s11 offen offset:3072 sc1 lds
  s_mov_b32 m0, 96256
  s_add_u32 s11, s58, 14336
  buffer_load_dwordx4 v44, s[52:55], s11 offen offset:0 sc1 lds
  buffer_load_dwordx4 v44, s[52:55], s11 offen offset:1024 sc1 lds
  buffer_load_dwordx4 v44, s[52:55], s11 offen offset:2048 sc1 lds
  buffer_load_dwordx4 v44, s[52:55], s11 offen offset:3072 sc1 lds
  s_mov_b32 m0, 100352
  s_add_u32 s11, s58, 18432
  buffer_load_dwordx4 v44, s[52:55], s11 offen offset:0 sc1 lds
  buffer_load_dwordx4 v44, s[52:55], s11 offen offset:1024 sc1 lds
  buffer_load_dwordx4 v44, s[52:55], s11 offen offset:2048 sc1 lds
  buffer_load_dwordx4 v44, s[52:55], s11 offen offset:3072 sc1 lds
  s_mov_b32 m0, 104448
  s_add_u32 s11, s58, 22528
  buffer_load_dwordx4 v44, s[52:55], s11 offen offset:0 sc1 lds
  buffer_load_dwordx4 v44, s[52:55], s11 offen offset:1024 sc1 lds
  buffer_load_dwordx4 v44, s[52:55], s11 offen offset:2048 sc1 lds
  s_add_u32 m0, s46, 0
  s_mov_b64 exec, 1
  buffer_load_dword off, s[76:79], 0 lds
  s_mov_b64 exec, -1
  s_add_u32 s46, s46, 4
  s_mov_b64 exec, 7
  s_waitcnt vmcnt(27)
  v_cmp_gt_u32 vcc, v9, v16
  s_mov_b64 exec, -1
  s_cbranch_vccnz SL_24
BK_25:
  s_mov_b32 m0, 1536
  s_nop 0
  buffer_load_dwordx4 v32, s[52:55], s61 offen offset:0 sc1 lds
  buffer_load_dwordx4 v33, s[52:55], s61 offen offset:1024 sc1 lds
  buffer_load_dwordx4 v34, s[52:55], s61 offen offset:2048 sc1 lds
  buffer_load_dwordx4 v35, s[52:55], s61 offen offset:3072 sc1 lds
  s_add_u32 s61, s61, 135168
  s_mov_b32 m0, 5632
  s_nop 0
  buffer_load_dwordx4 v32, s[52:55], s61 offen offset:0 sc1 lds
  buffer_load_dwordx4 v33, s[52:55], s61 offen offset:1024 sc1 lds
  buffer_load_dwordx4 v34, s[52:55], s61 offen offset:2048 sc1 lds
  buffer_load_dwordx4 v35, s[52:55], s61 offen offset:3072 sc1 lds
  s_add_u32 s61, s61, 135168
  s_mov_b32 m0, 9728
  s_nop 0
  buffer_load_dwordx4 v32, s[52:55], s61 offen offset:0 sc1 lds
  buffer_load_dwordx4 v33, s[52:55], s61 offen offset:1024 sc1 lds
  s_add_u32 m0, s46, 0
  s_mov_b64 exec, 1
  buffer_load_dword off, s[76:79], 0 lds
  s_mov_b64 exec, -1
  s_waitcnt vmcnt(0)
  s_endpgm
SL_1:
  v_and_b32 v17, 7, v0
  v_lshlrev_b32 v17, 2, v17
SP_3:
  global_load_dword v16, v17, s[42:43] sc1
  s_waitcnt vmcnt(0)
  v_cmp_eq_u32 vcc, 0, v16
  s_cbranch_vccz SO_4
  s_sleep 1
  s_sub_u32 s12, s12, 1
  s_cbranch_scc0 SP_3
  s_mov_b32 s12, 0
SO_4:
  s_branch BK_2
SL_5:
  v_lshlrev_b32 v17, 10, v0
  s_mov_b64 exec, 3
SP_7:
  v_mov_b32 v16, 0
  buffer_atomic_add v16, v17, s[48:51], s60 offen sc0 sc1
  s_waitcnt vmcnt(0)
  v_cmp_gt_u32 vcc, 24, v16
  s_cbranch_vccz SO_8
  s_sleep 8
  s_sub_u32 s12, s12, 1
  s_cbranch_scc0 SP_7
  s_mov_b32 s12, 0
SO_8:
  s_mov_b64 exec, -1
  s_branch BK_6
SL_24:
  v_lshlrev_b32 v17, 10, v0
  s_mov_b64 exec, 7
SP_26:
  v_mov_b32 v16, 0
  buffer_atomic_add v16, v17, s[48:51], s69 offen sc0 sc1
  s_waitcnt vmcnt(0)
  v_cmp_gt_u32 vcc, v9, v16
  s_cbranch_vccz SO_27
  s_sleep 8
  s_sub_u32 s12, s12, 1
  s_cbranch_scc0 SP_26
  s_mov_b32 s12, 0
SO_27:
  s_mov_b64 exec, -1
  s_branch BK_25
.p2align 6
R_s:
  s_setprio 1
  s_mov_b32 s12, 0x400000
  s_mul_i32 s9, s4, 43
  s_lshr_b32 s9, s9, 7
  s_mul_i32 s10, s9, 3
  s_sub_u32 s6, s4, s10
  s_lshr_b32 s6, s4, 3
  s_cmp_eq_u32 s6, 3
  s_cselect_b32 s6, 2, s6
  s_mov_b32 s48, s44
  s_and_b32 s49, s45, 0xffff
  s_mov_b32 s50, 16842752
  s_mov_b32 s51, 0x20000
  s_mul_i32 s61, s60, 6400
  s_add_u32 s61, s61, 15360
  s_mul_i32 s13, s5, 3
  s_add_u32 s13, s13, s60
  s_lshl_b32 s13, s13, 10
  s_add_u32 s13, s13, 16793600
  v_bfe_u32 v2, v0, 2, 1
  v_lshlrev_b32 v2, 4, v2
  v_mov_b32 v3, 0x3c00
  v_lshlrev_b32 v2, v2, v3
  v_bfe_u32 v3, v0, 3, 2
  v_lshrrev_b32 v4, 5, v0
  v_lshlrev_b32 v4, 1, v4
  v_sub_u32 v3, v3, v4
  v_and_b32 v4, 3, v0
  v_lshl_add_u32 v3, v3, 2, v4
  v_cmp_eq_u32 s[72:73], 0, v3
  v_cmp_eq_u32 s[74:75], 1, v3
  v_cmp_eq_u32 s[76:77], 2, v3
  v_cmp_eq_u32 s[78:79], 3, v3
  v_cndmask_b32 v92, 0, v2, s[72:73]
  v_cndmask_b32 v93, 0, v2, s[74:75]
  v_cndmask_b32 v94, 0, v2, s[76:77]
  v_cndmask_b32 v95, 0, v2, s[78:79]
  v_cmp_eq_u32 s[72:73], 4, v3
  v_cmp_eq_u32 s[74:75], 5, v3
  v_cmp_eq_u32 s[76:77], 6, v3
  v_cmp_eq_u32 s[78:79], 7, v3
  v_cndmask_b32 v96, 0, v2, s[72:73]
  v_cndmask_b32 v97, 0, v2, s[74:75]
  v_cndmask_b32 v98, 0, v2, s[76:77]
  v_cndmask_b32 v99, 0, v2, s[78:79]
  s_and_b32 s63, s8, 7
  s_mul_i32 s63, s63, 3
  s_lshr_b32 s63, s63, 3
  s_lshl_b32 s63, s63, 1
  s_lshr_b32 s77, s8, 3
  s_add_u32 s77, s77, s63
  s_sub_u32 s63, s77, 5
  s_cselect_b32 s77, s77, s63
  s_bfe_u32 s63, s2, 0x10001
  s_mul_i32 s46, s63, 40960
  s_add_u32 s46, s46, 40960
  s_lshl_b32 s63, s63, 2
  v_mov_b32 v226, s63
  v_bfe_u32 v2, v0, 2, 2
  v_lshrrev_b32 v3, 4, v0
  v_lshl_add_u32 v3, v3, 3, v2
  v_bfe_u32 v4, v0, 1, 1
  v_and_b32 v5, 1, v0
  v_lshlrev_b32 v5, 3, v5
  v_lshl_add_u32 v5, v3, 7, v5
  v_bfe_u32 v2, v3, 1, 3
  s_and_b32 s63, s5, 3
  s_mul_i32 s63, s63, 5
  s_add_u32 s63, s63, s60
  s_add_u32 s63, s63, 0
  s_min_u32 s63, s63, 19
  s_lshr_b32 s64, s63, 2
  s_sub_u32 s64, s64, s77
  s_cselect_b32 s65, 5, 0
  s_add_u32 s64, s64, s65
  s_lshl_b32 s64, s64, 13
  s_add_u32 s64, s64, s46
  s_and_b32 s63, s63, 3
  s_lshl_b32 s63, s63, 1
  v_add_u32 v6, s63, v4
  v_xor_b32 v6, v6, v2
  v_add_u32 v7, s64, v5
  v_xor_b32 v8, 0, v6
  v_lshl_add_u32 v8, v8, 4, v7
  v_xor_b32 v9, 2, v6
  v_lshl_add_u32 v9, v9, 4, v7
  s_add_u32 s63, s60, 0
  s_mul_i32 s78, s63, 67584
  s_mul_i32 s65, s5, 337920
  s_add_u32 s78, s78, s65
  s_lshl_b32 s65, s4, 7
  s_add_u32 s78, s78, s65
  s_add_u32 s78, s78, 8388608
  s_cmp_ge_u32 s63, 5
  s_cselect_b32 s78, 16842752, s78
  s_and_b32 s63, s5, 3
  s_mul_i32 s63, s63, 5
  s_add_u32 s63, s63, s60
  s_add_u32 s63, s63, 3
  s_min_u32 s63, s63, 19
  s_lshr_b32 s64, s63, 2
  s_sub_u32 s64, s64, s77
  s_cselect_b32 s65, 5, 0
  s_add_u32 s64, s64, s65
  s_lshl_b32 s64, s64, 13
  s_add_u32 s64, s64, s46
  s_and_b32 s63, s63, 3
  s_lshl_b32 s63, s63, 1
  v_add_u32 v6, s63, v4
  v_xor_b32 v6, v6, v2
  v_add_u32 v7, s64, v5
  v_xor_b32 v10, 0, v6
  v_lshl_add_u32 v10, v10, 4, v7
  v_xor_b32 v11, 2, v6
  v_lshl_add_u32 v11, v11, 4, v7
  s_add_u32 s63, s60, 3
  s_mul_i32 s79, s63, 67584
  s_mul_i32 s65, s5, 337920
  s_add_u32 s79, s79, s65
  s_lshl_b32 s65, s4, 7
  s_add_u32 s79, s79, s65
  s_add_u32 s79, s79, 8388608
  s_cmp_ge_u32 s63, 5
  s_cselect_b32 s79, 16842752, s79
  s_lshl_b32 s47, s60, 2
  v_and_b32 v13, 3, v0
  v_lshlrev_b32 v13, 2, v13
  v_lshrrev_b32 v5, 4, v0
  v_and_b32 v2, 7, v0
  v_lshl_add_u32 v2, v5, 3, v2
  v_bfe_u32 v4, v0, 3, 1
  v_lshl_add_u32 v2, v4, 5, v2
  v_lshlrev_b32 v12, 3, v2
  v_and_b32 v14, 15, v0
  v_mul_u32_u24 v14, 4224, v14
  v_lshl_add_u32 v14, v5, 4, v14
  v_mov_b32 v15, s47
  v_mov_b32 v1, 0
  s_barrier
  s_bitcmp1_b32 s62, 0
  s_cselect_b32 s76, 0, 16
  v_mov_b32 v44, 0x3fb8aa3b
  s_mov_b32 s72, 0x05040100
  s_mov_b32 s73, 0x07060302
  s_mov_b32 s74, 0xbfb8aa3b
  s_mov_b32 s75, 0x3e22f983
  s_waitcnt vmcnt(0) lgkmcnt(0)
  s_setprio 0
  s_lshl_b32 s67, s67, s76
  s_and_b32 s67, s67, 0xffff0000
  s_lshl_b32 s68, s68, s76
  s_and_b32 s68, s68, 0xffff0000
  s_lshl_b32 s69, s69, s76
  s_and_b32 s69, s69, 0xffff0000
  v_mul_f32 v44, s67, v44
  v_lshlrev_b32 v32, 16, v36
  v_and_b32 v36, 0xffff0000, v36
  v_lshlrev_b32 v40, 16, v40
  v_exp_f32 v44, v44
  v_mul_f32 v32, 0x3fb8aa3b, v32
  v_mul_f32 v36, 0x3fb8aa3b, v36
  v_mul_f32 v40, 0x3fb8aa3b, v40
  v_exp_f32 v32, v32
  v_exp_f32 v36, v36
  v_exp_f32 v40, v40
  v_cvt_pk_bf16_f32 v44, 0, v44
  v_lshlrev_b32 v33, 16, v37
  v_and_b32 v37, 0xffff0000, v37
  v_lshlrev_b32 v41, 16, v41
  v_cvt_pk_bf16_f32 v32, 0, v32
  v_cvt_pk_bf16_f32 v36, 0, v36
  v_cvt_pk_bf16_f32 v40, 0, v40
  v_pk_mul_f32 v[46:47], v[32:33], v[44:45] op_sel_hi:[1,0]
  v_pk_mul_f32 v[46:47], v[46:47], s[74:75]
  v_rndne_f32 v48, v47
  v_sub_f32 v51, v47, v48
  v_cos_f32 v48, v51
  v_sin_f32 v49, v51
  v_exp_f32 v50, v46
  v_lshlrev_b32 v34, 16, v38
  v_and_b32 v38, 0xffff0000, v38
  v_lshlrev_b32 v42, 16, v42
  v_pk_mul_f32 v[48:49], v[48:49], v[50:51] op_sel_hi:[1,0]
  v_cvt_pk_f16_f32 v54, v48, v49
  v_add_f32 v45, v34, v38
  v_pk_mul_f32 v[50:51], v[48:49], v[48:49] op_sel:[1,1] op_sel_hi:[0,1]
  v_pk_fma_f32 v[48:49], v[48:49], v[48:49], v[50:51] op_sel_hi:[1,0,1] neg_lo:[0,0,1]
  v_cvt_pk_f16_f32 v55, v48, v49
  v_add_f32 v45, v45, v42
  v_pk_mul_f32 v[50:51], v[48:49], v[48:49] op_sel:[1,1] op_sel_hi:[0,1]
  v_pk_fma_f32 v[48:49], v[48:49], v[48:49], v[50:51] op_sel_hi:[1,0,1] neg_lo:[0,0,1]
  v_cvt_pk_f16_f32 v56, v48, v49
  v_add_f32_dpp v45, v45, v45 row_ror:1 row_mask:0xf bank_mask:0xf
  v_pk_mul_f32 v[50:51], v[48:49], v[48:49] op_sel:[1,1] op_sel_hi:[0,1]
  v_pk_fma_f32 v[48:49], v[48:49], v[48:49], v[50:51] op_sel_hi:[1,0,1] neg_lo:[0,0,1]
  v_cvt_pk_f16_f32 v57, v48, v49
  v_add_f32_dpp v45, v45, v45 row_ror:2 row_mask:0xf bank_mask:0xf
  v_pk_mul_f32 v[50:51], v[48:49], v[48:49] op_sel:[1,1] op_sel_hi:[0,1]
  v_pk_fma_f32 v[48:49], v[48:49], v[48:49], v[50:51] op_sel_hi:[1,0,1] neg_lo:[0,0,1]
  v_cvt_pk_f16_f32 v58, v48, v49
  v_add_f32_dpp v45, v45, v45 row_ror:4 row_mask:0xf bank_mask:0xf
  v_pk_mul_f32 v[50:51], v[48:49], v[48:49] op_sel:[1,1] op_sel_hi:[0,1]
  v_pk_fma_f32 v[48:49], v[48:49], v[48:49], v[50:51] op_sel_hi:[1,0,1] neg_lo:[0,0,1]
  v_cvt_pk_f16_f32 v59, v48, v49
  v_add_f32_dpp v45, v45, v45 row_ror:8 row_mask:0xf bank_mask:0xf
  v_pk_mul_f32 v[50:51], v[48:49], v[48:49] op_sel:[1,1] op_sel_hi:[0,1]
  v_pk_fma_f32 v[48:49], v[48:49], v[48:49], v[50:51] op_sel_hi:[1,0,1] neg_lo:[0,0,1]
  v_cvt_pk_f16_f32 v60, v48, v49
  v_mov_b32 v3, v45
  v_pk_mul_f32 v[50:51], v[48:49], v[48:49] op_sel:[1,1] op_sel_hi:[0,1]
  v_pk_fma_f32 v[48:49], v[48:49], v[48:49], v[50:51] op_sel_hi:[1,0,1] neg_lo:[0,0,1]
  v_cvt_pk_f16_f32 v61, v48, v49
  v_permlane16_swap_b32 v45, v3
  v_add_f32 v45, v45, v3
  v_pk_mul_f32 v[50:51], v[48:49], v[48:49] op_sel:[1,1] op_sel_hi:[0,1]
  v_pk_fma_f32 v[48:49], v[48:49], v[48:49], v[50:51] op_sel_hi:[1,0,1] neg_lo:[0,0,1]
  v_cvt_pk_f16_f32 v62, v48, v49
  v_pk_mul_f32 v[50:51], v[48:49], v[48:49] op_sel:[1,1] op_sel_hi:[0,1]
  v_pk_fma_f32 v[48:49], v[48:49], v[48:49], v[50:51] op_sel_hi:[1,0,1] neg_lo:[0,0,1]
  v_cvt_pk_f16_f32 v63, v48, v49
  v_pk_mul_f32 v[50:51], v[48:49], v[48:49] op_sel:[1,1] op_sel_hi:[0,1]
  v_pk_fma_f32 v[48:49], v[48:49], v[48:49], v[50:51] op_sel_hi:[1,0,1] neg_lo:[0,0,1]
  v_cvt_pk_f16_f32 v64, v48, v49
  v_pk_mul_f32 v[46:47], v[36:37], v[44:45] op_sel_hi:[1,0]
  v_pk_mul_f32 v[46:47], v[46:47], s[74:75]
  v_rndne_f32 v48, v47
  v_sub_f32 v51, v47, v48
  v_cos_f32 v48, v51
  v_sin_f32 v49, v51
  v_exp_f32 v50, v46
  v_lshlrev_b32 v35, 16, v39
  v_and_b32 v39, 0xffff0000, v39
  v_lshlrev_b32 v43, 16, v43
  v_pk_mul_f32 v[48:49], v[48:49], v[50:51] op_sel_hi:[1,0]
  v_cvt_pk_f16_f32 v65, v48, v49
  v_max3_f32 v2, |v34|, |v35|, |v38|
  v_pk_mul_f32 v[50:51], v[48:49], v[48:49] op_sel:[1,1] op_sel_hi:[0,1]
  v_pk_fma_f32 v[48:49], v[48:49], v[48:49], v[50:51] op_sel_hi:[1,0,1] neg_lo:[0,0,1]
  v_cvt_pk_f16_f32 v66, v48, v49
  v_max3_f32 v3, |v39|, |v42|, |v43|
  v_pk_mul_f32 v[50:51], v[48:49], v[48:49] op_sel:[1,1] op_sel_hi:[0,1]
  v_pk_fma_f32 v[48:49], v[48:49], v[48:49], v[50:51] op_sel_hi:[1,0,1] neg_lo:[0,0,1]
  v_cvt_pk_f16_f32 v67, v48, v49
  v_max_u32 v2, v2, v3
  v_pk_mul_f32 v[50:51], v[48:49], v[48:49] op_sel:[1,1] op_sel_hi:[0,1]
  v_pk_fma_f32 v[48:49], v[48:49], v[48:49], v[50:51] op_sel_hi:[1,0,1] neg_lo:[0,0,1]
  v_cvt_pk_f16_f32 v68, v48, v49
  v_max_u32_dpp v2, v2, v2 row_ror:1 row_mask:0xf bank_mask:0xf
  v_pk_mul_f32 v[50:51], v[48:49], v[48:49] op_sel:[1,1] op_sel_hi:[0,1]
  v_pk_fma_f32 v[48:49], v[48:49], v[48:49], v[50:51] op_sel_hi:[1,0,1] neg_lo:[0,0,1]
  v_cvt_pk_f16_f32 v69, v48, v49
  v_max_u32_dpp v2, v2, v2 row_ror:2 row_mask:0xf bank_mask:0xf
  v_pk_mul_f32 v[50:51], v[48:49], v[48:49] op_sel:[1,1] op_sel_hi:[0,1]
  v_pk_fma_f32 v[48:49], v[48:49], v[48:49], v[50:51] op_sel_hi:[1,0,1] neg_lo:[0,0,1]
  v_cvt_pk_f16_f32 v70, v48, v49
  v_max_u32_dpp v2, v2, v2 row_ror:4 row_mask:0xf bank_mask:0xf
  v_pk_mul_f32 v[50:51], v[48:49], v[48:49] op_sel:[1,1] op_sel_hi:[0,1]
  v_pk_fma_f32 v[48:49], v[48:49], v[48:49], v[50:51] op_sel_hi:[1,0,1] neg_lo:[0,0,1]
  v_cvt_pk_f16_f32 v71, v48, v49
  v_max_u32_dpp v2, v2, v2 row_ror:8 row_mask:0xf bank_mask:0xf
  v_pk_mul_f32 v[50:51], v[48:49], v[48:49] op_sel:[1,1] op_sel_hi:[0,1]
  v_pk_fma_f32 v[48:49], v[48:49], v[48:49], v[50:51] op_sel_hi:[1,0,1] neg_lo:[0,0,1]
  v_cvt_pk_f16_f32 v72, v48, v49
  v_readlane_b32 s63, v2, 0
  v_readlane_b32 s64, v2, 16
  v_readlane_b32 s65, v2, 32
  v_readlane_b32 s66, v2, 48
  v_pk_mul_f32 v[50:51], v[48:49], v[48:49] op_sel:[1,1] op_sel_hi:[0,1]
  v_pk_fma_f32 v[48:49], v[48:49], v[48:49], v[50:51] op_sel_hi:[1,0,1] neg_lo:[0,0,1]
  v_cvt_pk_f16_f32 v73, v48, v49
  s_max_u32 s63, s63, s64
  s_max_u32 s65, s65, s66
  s_max_u32 s63, s63, s65
  s_and_b32 s63, s63, 0x7f800000
  s_max_u32 s63, s63, 0x800000
  s_min_u32 s63, s63, 0x7d800000
  s_sub_u32 s70, 0x7e800000, s63
  s_add_u32 s71, s63, 0x1000000
  v_pk_mul_f32 v[50:51], v[48:49], v[48:49] op_sel:[1,1] op_sel_hi:[0,1]
  v_pk_fma_f32 v[48:49], v[48:49], v[48:49], v[50:51] op_sel_hi:[1,0,1] neg_lo:[0,0,1]
  v_cvt_pk_f16_f32 v74, v48, v49
  v_pk_mul_f32 v[50:51], v[48:49], v[48:49] op_sel:[1,1] op_sel_hi:[0,1]
  v_pk_fma_f32 v[48:49], v[48:49], v[48:49], v[50:51] op_sel_hi:[1,0,1] neg_lo:[0,0,1]
  v_cvt_pk_f16_f32 v75, v48, v49
  v_pk_mul_f32 v[46:47], v[40:41], v[44:45] op_sel_hi:[1,0]
  v_pk_mul_f32 v[46:47], v[46:47], s[74:75]
  v_rndne_f32 v48, v47
  v_sub_f32 v51, v47, v48
  v_cos_f32 v48, v51
  v_sin_f32 v49, v51
  v_exp_f32 v50, v46
  v_mov_b32 v3, v45
  v_pk_mul_f32 v[48:49], v[48:49], v[50:51] op_sel_hi:[1,0]
  v_cvt_pk_f16_f32 v76, v48, v49
  v_pk_mul_f32 v[50:51], v[48:49], v[48:49] op_sel:[1,1] op_sel_hi:[0,1]
  v_pk_fma_f32 v[48:49], v[48:49], v[48:49], v[50:51] op_sel_hi:[1,0,1] neg_lo:[0,0,1]
  v_permlane32_swap_b32 v45, v3
  v_add_f32 v45, v45, v3
  v_mul_f32 v45, s70, v45
  v_cvt_pk_f16_f32 v77, v48, v49
  v_pk_mul_f32 v[50:51], v[48:49], v[48:49] op_sel:[1,1] op_sel_hi:[0,1]
  v_pk_fma_f32 v[48:49], v[48:49], v[48:49], v[50:51] op_sel_hi:[1,0,1] neg_lo:[0,0,1]
  v_pk_mul_f32 v[34:35], v[34:35], s[70:71] op_sel_hi:[1,0]
  v_cvt_pk_f16_f32 v78, v48, v49
  v_pk_mul_f32 v[50:51], v[48:49], v[48:49] op_sel:[1,1] op_sel_hi:[0,1]
  v_pk_fma_f32 v[48:49], v[48:49], v[48:49], v[50:51] op_sel_hi:[1,0,1] neg_lo:[0,0,1]
  v_cvt_pk_f16_f32 v87, v34, -v35
  v_cvt_pk_f16_f32 v79, v48, v49
  v_pk_mul_f32 v[50:51], v[48:49], v[48:49] op_sel:[1,1] op_sel_hi:[0,1]
  v_pk_fma_f32 v[48:49], v[48:49], v[48:49], v[50:51] op_sel_hi:[1,0,1] neg_lo:[0,0,1]
  v_pk_mul_f32 v[38:39], v[38:39], s[70:71] op_sel_hi:[1,0]
  v_cvt_pk_f16_f32 v80, v48, v49
  v_pk_mul_f32 v[50:51], v[48:49], v[48:49] op_sel:[1,1] op_sel_hi:[0,1]
  v_pk_fma_f32 v[48:49], v[48:49], v[48:49], v[50:51] op_sel_hi:[1,0,1] neg_lo:[0,0,1]
  v_cvt_pk_f16_f32 v88, v38, -v39
  v_cvt_pk_f16_f32 v81, v48, v49
  v_pk_mul_f32 v[50:51], v[48:49], v[48:49] op_sel:[1,1] op_sel_hi:[0,1]
  v_pk_fma_f32 v[48:49], v[48:49], v[48:49], v[50:51] op_sel_hi:[1,0,1] neg_lo:[0,0,1]
  v_pk_mul_f32 v[42:43], v[42:43], s[70:71] op_sel_hi:[1,0]
  v_cvt_pk_f16_f32 v82, v48, v49
  v_pk_mul_f32 v[50:51], v[48:49], v[48:49] op_sel:[1,1] op_sel_hi:[0,1]
  v_pk_fma_f32 v[48:49], v[48:49], v[48:49], v[50:51] op_sel_hi:[1,0,1] neg_lo:[0,0,1]
  v_cvt_pk_f16_f32 v89, v42, -v43
  v_cvt_pk_f16_f32 v83, v48, v49
  v_pk_mul_f32 v[50:51], v[48:49], v[48:49] op_sel:[1,1] op_sel_hi:[0,1]
  v_pk_fma_f32 v[48:49], v[48:49], v[48:49], v[50:51] op_sel_hi:[1,0,1] neg_lo:[0,0,1]
  v_cvt_pk_f16_f32 v84, v48, v49
  v_pk_mul_f32 v[50:51], v[48:49], v[48:49] op_sel:[1,1] op_sel_hi:[0,1]
  v_pk_fma_f32 v[48:49], v[48:49], v[48:49], v[50:51] op_sel_hi:[1,0,1] neg_lo:[0,0,1]
  v_cvt_pk_f16_f32 v85, v48, v49
  v_pk_mul_f32 v[50:51], v[48:49], v[48:49] op_sel:[1,1] op_sel_hi:[0,1]
  v_pk_fma_f32 v[48:49], v[48:49], v[48:49], v[50:51] op_sel_hi:[1,0,1] neg_lo:[0,0,1]
  v_cvt_pk_f16_f32 v86, v48, v49
  v_mov_b32 v46, 0x3c00
  v_pk_mul_f16 v50, v87, v60 op_sel:[1,1] op_sel_hi:[0,1]
  v_pk_fma_f16 v52, v87, v60, v50 op_sel_hi:[1,0,1] neg_hi:[0,0,1]
  v_perm_b32 v124, v52, v87, s72
  v_perm_b32 v128, v52, v87, s73
  v_pk_mul_f16 v50, v54, v128 op_sel:[1,0] op_sel_hi:[1,1]
  v_pk_mul_f16 v51, v54, v124 op_sel:[1,0] op_sel_hi:[1,1]
  v_pk_fma_f16 v100, v124, v54, v50 op_sel_hi:[1,0,1]
  v_pk_fma_f16 v104, v128, v54, v51 op_sel_hi:[1,0,1] neg_lo:[0,0,1] neg_hi:[0,0,1]
  v_pk_mul_f16 v50, v55, v128 op_sel:[1,0] op_sel_hi:[1,1]
  v_pk_mul_f16 v51, v55, v124 op_sel:[1,0] op_sel_hi:[1,1]
  v_pk_fma_f16 v101, v124, v55, v50 op_sel_hi:[1,0,1]
  v_pk_fma_f16 v105, v128, v55, v51 op_sel_hi:[1,0,1] neg_lo:[0,0,1] neg_hi:[0,0,1]
  v_pk_mul_f16 v50, v55, v104 op_sel:[1,0] op_sel_hi:[1,1]
  v_pk_mul_f16 v51, v55, v100 op_sel:[1,0] op_sel_hi:[1,1]
  v_pk_fma_f16 v102, v100, v55, v50 op_sel_hi:[1,0,1]
  v_pk_fma_f16 v106, v104, v55, v51 op_sel_hi:[1,0,1] neg_lo:[0,0,1] neg_hi:[0,0,1]
  v_pk_mul_f16 v50, v56, v128 op_sel:[1,0] op_sel_hi:[1,1]
  v_pk_mul_f16 v51, v56, v124 op_sel:[1,0] op_sel_hi:[1,1]
  v_pk_fma_f16 v103, v124, v56, v50 op_sel_hi:[1,0,1]
  v_pk_fma_f16 v107, v128, v56, v51 op_sel_hi:[1,0,1] neg_lo:[0,0,1] neg_hi:[0,0,1]
  v_pk_mul_f16 v50, v62, v105 op_sel:[1,0] op_sel_hi:[1,1]
  v_pk_mul_f16 v51, v62, v101 op_sel:[1,0] op_sel_hi:[1,1]
  v_pk_fma_f16 v108, v101, v62, v50 op_sel_hi:[1,0,1]
  v_pk_fma_f16 v112, v105, v62, v51 op_sel_hi:[1,0,1] neg_lo:[0,0,1] neg_hi:[0,0,1]
  v_pk_mul_f16 v50, v62, v107 op_sel:[1,0] op_sel_hi:[1,1]
  v_pk_mul_f16 v51, v62, v103 op_sel:[1,0] op_sel_hi:[1,1]
  v_pk_fma_f16 v109, v103, v62, v50 op_sel_hi:[1,0,1]
  v_pk_fma_f16 v113, v107, v62, v51 op_sel_hi:[1,0,1] neg_lo:[0,0,1] neg_hi:[0,0,1]
  v_pk_mul_f16 v50, v63, v107 op_sel:[1,0] op_sel_hi:[1,1]
  v_pk_mul_f16 v51, v63, v103 op_sel:[1,0] op_sel_hi:[1,1]
  v_pk_fma_f16 v110, v103, v63, v50 op_sel_hi:[1,0,1]
  v_pk_fma_f16 v114, v107, v63, v51 op_sel_hi:[1,0,1] neg_lo:[0,0,1] neg_hi:[0,0,1]
  v_pk_mul_f16 v50, v63, v113 op_sel:[1,0] op_sel_hi:[1,1]
  v_pk_mul_f16 v51, v63, v109 op_sel:[1,0] op_sel_hi:[1,1]
  v_pk_fma_f16 v111, v109, v63, v50 op_sel_hi:[1,0,1]
  v_pk_fma_f16 v115, v113, v63, v51 op_sel_hi:[1,0,1] neg_lo:[0,0,1] neg_hi:[0,0,1]
  s_setprio 3
  v_mfma_f32_32x32x16_f16 v[164:179], v[100:103], v[92:95], 0
  s_setprio 0
  v_pk_mul_f16 v50, v64, v107 op_sel:[1,0] op_sel_hi:[1,1]
  v_pk_mul_f16 v51, v64, v103 op_sel:[1,0] op_sel_hi:[1,1]
  v_pk_fma_f16 v116, v103, v64, v50 op_sel_hi:[1,0,1]
  v_pk_fma_f16 v120, v107, v64, v51 op_sel_hi:[1,0,1] neg_lo:[0,0,1] neg_hi:[0,0,1]
  v_pk_mul_f16 v50, v64, v113 op_sel:[1,0] op_sel_hi:[1,1]
  s_setprio 3
  v_mfma_f32_32x32x16_f16 v[164:179], v[108:111], v[96:99], v[164:179]
  s_setprio 0
  v_pk_mul_f16 v51, v64, v109 op_sel:[1,0] op_sel_hi:[1,1]
  v_pk_fma_f16 v117, v109, v64, v50 op_sel_hi:[1,0,1]
  v_pk_fma_f16 v121, v113, v64, v51 op_sel_hi:[1,0,1] neg_lo:[0,0,1] neg_hi:[0,0,1]
  v_pk_mul_f16 v50, v64, v114 op_sel:[1,0] op_sel_hi:[1,1]
  v_pk_mul_f16 v51, v64, v110 op_sel:[1,0] op_sel_hi:[1,1]
  s_setprio 3
  v_mfma_f32_32x32x16_f16 v[180:195], v[104:107], v[92:95], 0
  s_setprio 0
  v_pk_fma_f16 v118, v110, v64, v50 op_sel_hi:[1,0,1]
  v_pk_fma_f16 v122, v114, v64, v51 op_sel_hi:[1,0,1] neg_lo:[0,0,1] neg_hi:[0,0,1]
  v_pk_mul_f16 v50, v64, v115 op_sel:[1,0] op_sel_hi:[1,1]
  v_pk_mul_f16 v51, v64, v111 op_sel:[1,0] op_sel_hi:[1,1]
  v_pk_fma_f16 v119, v111, v64, v50 op_sel_hi:[1,0,1]
  s_setprio 3
  v_mfma_f32_32x32x16_f16 v[180:195], v[112:115], v[96:99], v[180:195]
  s_setprio 0
  v_pk_fma_f16 v123, v115, v64, v51 op_sel_hi:[1,0,1] neg_lo:[0,0,1] neg_hi:[0,0,1]
  v_lshl_or_b32 v132, v58, 16, v46
  v_and_b32 v136, 0xffff0000, v58
  v_pk_mul_f16 v50, v56, v136 op_sel:[1,0] op_sel_hi:[1,1]
  v_pk_mul_f16 v51, v56, v132 op_sel:[1,0] op_sel_hi:[1,1]
  v_pk_fma_f16 v133, v132, v56, v50 op_sel_hi:[1,0,1] neg_lo:[0,0,1] neg_hi:[0,0,1]
  v_pk_fma_f16 v137, v136, v56, v51 op_sel_hi:[1,0,1]
  v_pk_mul_f16 v50, v57, v136 op_sel:[1,0] op_sel_hi:[1,1]
  v_pk_mul_f16 v51, v57, v132 op_sel:[1,0] op_sel_hi:[1,1]
  v_pk_fma_f16 v134, v132, v57, v50 op_sel_hi:[1,0,1] neg_lo:[0,0,1] neg_hi:[0,0,1]
  v_pk_fma_f16 v138, v136, v57, v51 op_sel_hi:[1,0,1]
  v_pk_mul_f16 v50, v57, v137 op_sel:[1,0] op_sel_hi:[1,1]
  v_pk_mul_f16 v51, v57, v133 op_sel:[1,0] op_sel_hi:[1,1]
  v_pk_fma_f16 v135, v133, v57, v50 op_sel_hi:[1,0,1] neg_lo:[0,0,1] neg_hi:[0,0,1]
  v_pk_fma_f16 v139, v137, v57, v51 op_sel_hi:[1,0,1]
  v_cvt_pk_f16_f32 v100, v164, v165
  v_cvt_pk_f16_f32 v101, v166, v167
  v_cvt_pk_f16_f32 v102, v168, v169
  v_cvt_pk_f16_f32 v103, v170, v171
  v_cvt_pk_f16_f32 v104, v172, v173
  v_cvt_pk_f16_f32 v105, v174, v175
  v_cvt_pk_f16_f32 v106, v176, v177
  v_cvt_pk_f16_f32 v107, v178, v179
  v_cvt_pk_f16_f32 v108, v180, v181
  v_cvt_pk_f16_f32 v109, v182, v183
  v_cvt_pk_f16_f32 v110, v184, v185
  v_cvt_pk_f16_f32 v111, v186, v187
  v_cvt_pk_f16_f32 v112, v188, v189
  v_cvt_pk_f16_f32 v113, v190, v191
  v_cvt_pk_f16_f32 v114, v192, v193
  v_cvt_pk_f16_f32 v115, v194, v195
  s_setprio 3
  v_mfma_f32_32x32x16_f16 v[164:179], v[116:119], v[92:95], 0
  s_setprio 0
  v_pk_mul_f16 v50, v59, v136 op_sel:[1,0] op_sel_hi:[1,1]
  v_pk_mul_f16 v51, v59, v132 op_sel:[1,0] op_sel_hi:[1,1]
  v_pk_fma_f16 v140, v132, v59, v50 op_sel_hi:[1,0,1] neg_lo:[0,0,1] neg_hi:[0,0,1]
  v_pk_fma_f16 v144, v136, v59, v51 op_sel_hi:[1,0,1]
  v_pk_mul_f16 v50, v59, v137 op_sel:[1,0] op_sel_hi:[1,1]
  s_setprio 3
  v_mfma_f32_32x32x16_f16 v[180:195], v[120:123], v[92:95], 0
  s_setprio 0
  v_pk_mul_f16 v51, v59, v133 op_sel:[1,0] op_sel_hi:[1,1]
  v_pk_fma_f16 v141, v133, v59, v50 op_sel_hi:[1,0,1] neg_lo:[0,0,1] neg_hi:[0,0,1]
  v_pk_fma_f16 v145, v137, v59, v51 op_sel_hi:[1,0,1]
  v_pk_mul_f16 v50, v59, v138 op_sel:[1,0] op_sel_hi:[1,1]
  v_pk_mul_f16 v51, v59, v134 op_sel:[1,0] op_sel_hi:[1,1]
  v_pk_fma_f16 v142, v134, v59, v50 op_sel_hi:[1,0,1] neg_lo:[0,0,1] neg_hi:[0,0,1]
  v_pk_fma_f16 v146, v138, v59, v51 op_sel_hi:[1,0,1]
  v_pk_mul_f16 v50, v59, v139 op_sel:[1,0] op_sel_hi:[1,1]
  v_pk_mul_f16 v51, v59, v135 op_sel:[1,0] op_sel_hi:[1,1]
  v_pk_fma_f16 v143, v135, v59, v50 op_sel_hi:[1,0,1] neg_lo:[0,0,1] neg_hi:[0,0,1]
  v_pk_fma_f16 v147, v139, v59, v51 op_sel_hi:[1,0,1]
  v_pk_mul_f16 v50, v61, v136 op_sel:[1,0] op_sel_hi:[1,1]
  v_pk_mul_f16 v51, v61, v132 op_sel:[1,0] op_sel_hi:[1,1]
  v_pk_fma_f16 v148, v132, v61, v50 op_sel_hi:[1,0,1] neg_lo:[0,0,1] neg_hi:[0,0,1]
  v_pk_fma_f16 v152, v136, v61, v51 op_sel_hi:[1,0,1]
  v_pk_mul_f16 v50, v61, v137 op_sel:[1,0] op_sel_hi:[1,1]
  v_pk_mul_f16 v51, v61, v133 op_sel:[1,0] op_sel_hi:[1,1]
  v_pk_fma_f16 v149, v133, v61, v50 op_sel_hi:[1,0,1] neg_lo:[0,0,1] neg_hi:[0,0,1]
  v_pk_fma_f16 v153, v137, v61, v51 op_sel_hi:[1,0,1]
  v_cvt_pk_f16_f32 v116, v164, v165
  v_cvt_pk_f16_f32 v117, v166, v167
  v_cvt_pk_f16_f32 v118, v168, v169
  v_cvt_pk_f16_f32 v119, v170, v171
  v_cvt_pk_f16_f32 v120, v172, v173
  v_cvt_pk_f16_f32 v121, v174, v175
  v_cvt_pk_f16_f32 v122, v176, v177
  v_cvt_pk_f16_f32 v123, v178, v179
  v_cvt_pk_f16_f32 v124, v180, v181
  v_cvt_pk_f16_f32 v125, v182, v183
  v_cvt_pk_f16_f32 v126, v184, v185
  v_cvt_pk_f16_f32 v127, v186, v187
  v_cvt_pk_f16_f32 v128, v188, v189
  v_cvt_pk_f16_f32 v129, v190, v191
  v_cvt_pk_f16_f32 v130, v192, v193
  v_cvt_pk_f16_f32 v131, v194, v195
  s_setprio 3
  v_mfma_f32_32x32x16_f16 v[164:179], v[132:135], v[92:95], 0
  s_setprio 0
  v_pk_mul_f16 v50, v61, v138 op_sel:[1,0] op_sel_hi:[1,1]
  v_pk_mul_f16 v51, v61, v134 op_sel:[1,0] op_sel_hi:[1,1]
  v_pk_fma_f16 v150, v134, v61, v50 op_sel_hi:[1,0,1] neg_lo:[0,0,1] neg_hi:[0,0,1]
  v_pk_fma_f16 v154, v138, v61, v51 op_sel_hi:[1,0,1]
  v_pk_mul_f16 v50, v61, v139 op_sel:[1,0] op_sel_hi:[1,1]
  s_setprio 3
  v_mfma_f32_32x32x16_f16 v[164:179], v[140:143], v[96:99], v[164:179]
  s_setprio 0
  v_pk_mul_f16 v51, v61, v135 op_sel:[1,0] op_sel_hi:[1,1]
  v_pk_fma_f16 v151, v135, v61, v50 op_sel_hi:[1,0,1] neg_lo:[0,0,1] neg_hi:[0,0,1]
  v_pk_fma_f16 v155, v139, v61, v51 op_sel_hi:[1,0,1]
  v_pk_mul_f16 v50, v61, v144 op_sel:[1,0] op_sel_hi:[1,1]
  v_pk_mul_f16 v51, v61, v140 op_sel:[1,0] op_sel_hi:[1,1]
  s_setprio 3
  v_mfma_f32_32x32x16_f16 v[180:195], v[136:139], v[92:95], 0
  s_setprio 0
  v_pk_fma_f16 v156, v140, v61, v50 op_sel_hi:[1,0,1] neg_lo:[0,0,1] neg_hi:[0,0,1]
  v_pk_fma_f16 v160, v144, v61, v51 op_sel_hi:[1,0,1]
  v_pk_mul_f16 v50, v61, v145 op_sel:[1,0] op_sel_hi:[1,1]
  v_pk_mul_f16 v51, v61, v141 op_sel:[1,0] op_sel_hi:[1,1]
  v_pk_fma_f16 v157, v141, v61, v50 op_sel_hi:[1,0,1] neg_lo:[0,0,1] neg_hi:[0,0,1]
  s_setprio 3
  v_mfma_f32_32x32x16_f16 v[180:195], v[144:147], v[96:99], v[180:195]
  s_setprio 0
  v_pk_fma_f16 v161, v145, v61, v51 op_sel_hi:[1,0,1]
  v_pk_mul_f16 v50, v61, v146 op_sel:[1,0] op_sel_hi:[1,1]
  v_pk_mul_f16 v51, v61, v142 op_sel:[1,0] op_sel_hi:[1,1]
  v_pk_fma_f16 v158, v142, v61, v50 op_sel_hi:[1,0,1] neg_lo:[0,0,1] neg_hi:[0,0,1]
  v_pk_fma_f16 v162, v146, v61, v51 op_sel_hi:[1,0,1]
  v_pk_mul_f16 v50, v61, v147 op_sel:[1,0] op_sel_hi:[1,1]
  v_pk_mul_f16 v51, v61, v143 op_sel:[1,0] op_sel_hi:[1,1]
  v_pk_fma_f16 v159, v143, v61, v50 op_sel_hi:[1,0,1] neg_lo:[0,0,1] neg_hi:[0,0,1]
  v_pk_fma_f16 v163, v147, v61, v51 op_sel_hi:[1,0,1]
  v_cvt_pk_f16_f32 v132, v164, v165
  v_cvt_pk_f16_f32 v133, v166, v167
  v_cvt_pk_f16_f32 v134, v168, v169
  v_cvt_pk_f16_f32 v135, v170, v171
  v_cvt_pk_f16_f32 v136, v172, v173
  v_cvt_pk_f16_f32 v137, v174, v175
  v_cvt_pk_f16_f32 v138, v176, v177
  v_cvt_pk_f16_f32 v139, v178, v179
  s_setprio 3
  v_mfma_f32_32x32x16_f16 v[164:179], v[148:151], v[92:95], 0
  s_setprio 0
  v_cvt_pk_f16_f32 v140, v180, v181
  v_cvt_pk_f16_f32 v141, v182, v183
  v_cvt_pk_f16_f32 v142, v184, v185
  v_cvt_pk_f16_f32 v143, v186, v187
  s_setprio 3
  v_mfma_f32_32x32x16_f16 v[164:179], v[156:159], v[96:99], v[164:179]
  s_setprio 0
  v_cvt_pk_f16_f32 v144, v188, v189
  v_cvt_pk_f16_f32 v145, v190, v191
  v_cvt_pk_f16_f32 v146, v192, v193
  v_cvt_pk_f16_f32 v147, v194, v195
  s_setprio 3
  v_mfma_f32_32x32x16_f16 v[180:195], v[152:155], v[92:95], 0
  v_mfma_f32_32x32x16_f16 v[180:195], v[160:163], v[96:99], v[180:195]
  v_mfma_f32_16x16x32_f16 v[16:19], v[100:103], v[132:135], 0
  v_mfma_f32_16x16x32_f16 v[24:27], v[116:119], v[132:135], 0
  v_mfma_f32_16x16x32_f16 v[16:19], v[104:107], v[136:139], v[16:19]
  v_mfma_f32_16x16x32_f16 v[24:27], v[120:123], v[136:139], v[24:27]
  v_mfma_f32_16x16x32_f16 v[16:19], v[108:111], v[140:143], v[16:19]
  v_mfma_f32_16x16x32_f16 v[24:27], v[124:127], v[140:143], v[24:27]
  v_mfma_f32_16x16x32_f16 v[16:19], v[112:115], v[144:147], v[16:19]
  v_mfma_f32_16x16x32_f16 v[24:27], v[128:131], v[144:147], v[24:27]
  s_setprio 0
  v_cvt_pk_f16_f32 v148, v164, v165
  v_cvt_pk_f16_f32 v149, v166, v167
  v_cvt_pk_f16_f32 v150, v168, v169
  v_cvt_pk_f16_f32 v151, v170, v171
  v_cvt_pk_f16_f32 v152, v172, v173
  v_cvt_pk_f16_f32 v153, v174, v175
  v_cvt_pk_f16_f32 v154, v176, v177
  v_cvt_pk_f16_f32 v155, v178, v179
  s_setprio 3
  v_mfma_f32_16x16x32_f16 v[20:23], v[100:103], v[148:151], 0
  v_mfma_f32_16x16x32_f16 v[28:31], v[116:119], v[148:151], 0
  s_setprio 0
  v_cvt_pk_f16_f32 v156, v180, v181
  v_cvt_pk_f16_f32 v157, v182, v183
  v_cvt_pk_f16_f32 v158, v184, v185
  v_cvt_pk_f16_f32 v159, v186, v187
  s_setprio 3
  v_mfma_f32_16x16x32_f16 v[20:23], v[104:107], v[152:155], v[20:23]
  v_mfma_f32_16x16x32_f16 v[28:31], v[120:123], v[152:155], v[28:31]
  s_setprio 0
  v_cvt_pk_f16_f32 v160, v188, v189
  v_cvt_pk_f16_f32 v161, v190, v191
  v_cvt_pk_f16_f32 v162, v192, v193
  v_cvt_pk_f16_f32 v163, v194, v195
  s_setprio 3
  v_mfma_f32_16x16x32_f16 v[20:23], v[108:111], v[156:159], v[20:23]
  v_mfma_f32_16x16x32_f16 v[28:31], v[124:127], v[156:159], v[28:31]
  v_mfma_f32_16x16x32_f16 v[20:23], v[112:115], v[160:163], v[20:23]
  v_mfma_f32_16x16x32_f16 v[28:31], v[128:131], v[160:163], v[28:31]
  s_setprio 0
SP_44:
  ds_read_b32 v3, v226 offset:1024
  s_waitcnt lgkmcnt(0)
  v_cmp_ne_u32 vcc, 0, v3
  s_cbranch_vccz SO_45
  s_sleep 2
  s_sub_u32 s12, s12, 1
  s_cbranch_scc0 SP_44
  s_mov_b32 s12, 0
SO_45:
  ds_read_b64_tr_b16 v[208:209], v8 offset:0
  ds_read_b64_tr_b16 v[210:211], v9 offset:512
  ds_read_b64_tr_b16 v[212:213], v8 offset:4096
  ds_read_b64_tr_b16 v[214:215], v9 offset:4608
  ds_read_b64_tr_b16 v[216:217], v10 offset:0
  ds_read_b64_tr_b16 v[218:219], v11 offset:512
  ds_read_b64_tr_b16 v[220:221], v10 offset:4096
  ds_read_b64_tr_b16 v[222:223], v11 offset:4608
  s_mov_b64 exec, 1
  ds_write_b32 v15, v1 offset:1264
  s_mov_b64 exec, -1
  v_pk_mul_f16 v50, v88, v71 op_sel:[1,1] op_sel_hi:[0,1]
  v_pk_fma_f16 v52, v88, v71, v50 op_sel_hi:[1,0,1] neg_hi:[0,0,1]
  v_perm_b32 v124, v52, v88, s72
  v_perm_b32 v128, v52, v88, s73
  v_pk_mul_f16 v50, v65, v128 op_sel:[1,0] op_sel_hi:[1,1]
  v_pk_mul_f16 v51, v65, v124 op_sel:[1,0] op_sel_hi:[1,1]
  v_pk_fma_f16 v100, v124, v65, v50 op_sel_hi:[1,0,1]
  v_pk_fma_f16 v104, v128, v65, v51 op_sel_hi:[1,0,1] neg_lo:[0,0,1] neg_hi:[0,0,1]
  v_pk_mul_f16 v50, v66, v128 op_sel:[1,0] op_sel_hi:[1,1]
  v_pk_mul_f16 v51, v66, v124 op_sel:[1,0] op_sel_hi:[1,1]
  v_pk_fma_f16 v101, v124, v66, v50 op_sel_hi:[1,0,1]
  v_pk_fma_f16 v105, v128, v66, v51 op_sel_hi:[1,0,1] neg_lo:[0,0,1] neg_hi:[0,0,1]
  v_pk_mul_f16 v50, v66, v104 op_sel:[1,0] op_sel_hi:[1,1]
  v_pk_mul_f16 v51, v66, v100 op_sel:[1,0] op_sel_hi:[1,1]
  v_pk_fma_f16 v102, v100, v66, v50 op_sel_hi:[1,0,1]
  v_pk_fma_f16 v106, v104, v66, v51 op_sel_hi:[1,0,1] neg_lo:[0,0,1] neg_hi:[0,0,1]
  v_pk_mul_f16 v50, v67, v128 op_sel:[1,0] op_sel_hi:[1,1]
  v_pk_mul_f16 v51, v67, v124 op_sel:[1,0] op_sel_hi:[1,1]
  v_pk_fma_f16 v103, v124, v67, v50 op_sel_hi:[1,0,1]
  v_pk_fma_f16 v107, v128, v67, v51 op_sel_hi:[1,0,1] neg_lo:[0,0,1] neg_hi:[0,0,1]
  v_pk_mul_f16 v50, v73, v105 op_sel:[1,0] op_sel_hi:[1,1]
  v_pk_mul_f16 v51, v73, v101 op_sel:[1,0] op_sel_hi:[1,1]
  v_pk_fma_f16 v108, v101, v73, v50 op_sel_hi:[1,0,1]
  v_pk_fma_f16 v112, v105, v73, v51 op_sel_hi:[1,0,1] neg_lo:[0,0,1] neg_hi:[0,0,1]
  v_pk_mul_f16 v50, v73, v107 op_sel:[1,0] op_sel_hi:[1,1]
  v_pk_mul_f16 v51, v73, v103 op_sel:[1,0] op_sel_hi:[1,1]
  v_pk_fma_f16 v109, v103, v73, v50 op_sel_hi:[1,0,1]
  v_pk_fma_f16 v113, v107, v73, v51 op_sel_hi:[1,0,1] neg_lo:[0,0,1] neg_hi:[0,0,1]
  v_pk_mul_f16 v50, v74, v107 op_sel:[1,0] op_sel_hi:[1,1]
  v_pk_mul_f16 v51, v74, v103 op_sel:[1,0] op_sel_hi:[1,1]
  v_pk_fma_f16 v110, v103, v74, v50 op_sel_hi:[1,0,1]
  v_pk_fma_f16 v114, v107, v74, v51 op_sel_hi:[1,0,1] neg_lo:[0,0,1] neg_hi:[0,0,1]
  v_pk_mul_f16 v50, v74, v113 op_sel:[1,0] op_sel_hi:[1,1]
  v_pk_mul_f16 v51, v74, v109 op_sel:[1,0] op_sel_hi:[1,1]
  v_pk_fma_f16 v111, v109, v74, v50 op_sel_hi:[1,0,1]
  v_pk_fma_f16 v115, v113, v74, v51 op_sel_hi:[1,0,1] neg_lo:[0,0,1] neg_hi:[0,0,1]
  s_setprio 3
  v_mfma_f32_32x32x16_f16 v[164:179], v[100:103], v[92:95], 0
  s_setprio 0
  v_pk_mul_f16 v50, v75, v107 op_sel:[1,0] op_sel_hi:[1,1]
  v_pk_mul_f16 v51, v75, v103 op_sel:[1,0] op_sel_hi:[1,1]
  v_pk_fma_f16 v116, v103, v75, v50 op_sel_hi:[1,0,1]
  v_pk_fma_f16 v120, v107, v75, v51 op_sel_hi:[1,0,1] neg_lo:[0,0,1] neg_hi:[0,0,1]
  v_pk_mul_f16 v50, v75, v113 op_sel:[1,0] op_sel_hi:[1,1]
  s_setprio 3
  v_mfma_f32_32x32x16_f16 v[164:179], v[108:111], v[96:99], v[164:179]
  s_setprio 0
  v_pk_mul_f16 v51, v75, v109 op_sel:[1,0] op_sel_hi:[1,1]
  v_pk_fma_f16 v117, v109, v75, v50 op_sel_hi:[1,0,1]
  v_pk_fma_f16 v121, v113, v75, v51 op_sel_hi:[1,0,1] neg_lo:[0,0,1] neg_hi:[0,0,1]
  v_pk_mul_f16 v50, v75, v114 op_sel:[1,0] op_sel_hi:[1,1]
  v_pk_mul_f16 v51, v75, v110 op_sel:[1,0] op_sel_hi:[1,1]
  s_setprio 3
  v_mfma_f32_32x32x16_f16 v[180:195], v[104:107], v[92:95], 0
  s_setprio 0
  v_pk_fma_f16 v118, v110, v75, v50 op_sel_hi:[1,0,1]
  v_pk_fma_f16 v122, v114, v75, v51 op_sel_hi:[1,0,1] neg_lo:[0,0,1] neg_hi:[0,0,1]
  v_pk_mul_f16 v50, v75, v115 op_sel:[1,0] op_sel_hi:[1,1]
  v_pk_mul_f16 v51, v75, v111 op_sel:[1,0] op_sel_hi:[1,1]
  v_pk_fma_f16 v119, v111, v75, v50 op_sel_hi:[1,0,1]
  s_setprio 3
  v_mfma_f32_32x32x16_f16 v[180:195], v[112:115], v[96:99], v[180:195]
  s_setprio 0
  v_pk_fma_f16 v123, v115, v75, v51 op_sel_hi:[1,0,1] neg_lo:[0,0,1] neg_hi:[0,0,1]
  v_lshl_or_b32 v132, v69, 16, v46
  v_and_b32 v136, 0xffff0000, v69
  v_pk_mul_f16 v50, v67, v136 op_sel:[1,0] op_sel_hi:[1,1]
  v_pk_mul_f16 v51, v67, v132 op_sel:[1,0] op_sel_hi:[1,1]
  v_pk_fma_f16 v133, v132, v67, v50 op_sel_hi:[1,0,1] neg_lo:[0,0,1] neg_hi:[0,0,1]
  v_pk_fma_f16 v137, v136, v67, v51 op_sel_hi:[1,0,1]
  v_pk_mul_f16 v50, v68, v136 op_sel:[1,0] op_sel_hi:[1,1]
  v_pk_mul_f16 v51, v68, v132 op_sel:[1,0] op_sel_hi:[1,1]
  v_pk_fma_f16 v134, v132, v68, v50 op_sel_hi:[1,0,1] neg_lo:[0,0,1] neg_hi:[0,0,1]
  v_pk_fma_f16 v138, v136, v68, v51 op_sel_hi:[1,0,1]
  v_pk_mul_f16 v50, v68, v137 op_sel:[1,0] op_sel_hi:[1,1]
  v_pk_mul_f16 v51, v68, v133 op_sel:[1,0] op_sel_hi:[1,1]
  v_pk_fma_f16 v135, v133, v68, v50 op_sel_hi:[1,0,1] neg_lo:[0,0,1] neg_hi:[0,0,1]
  v_pk_fma_f16 v139, v137, v68, v51 op_sel_hi:[1,0,1]
  v_cvt_pk_f16_f32 v100, v164, v165
  v_cvt_pk_f16_f32 v101, v166, v167
  v_cvt_pk_f16_f32 v102, v168, v169
  v_cvt_pk_f16_f32 v103, v170, v171
  v_cvt_pk_f16_f32 v104, v172, v173
  v_cvt_pk_f16_f32 v105, v174, v175
  v_cvt_pk_f16_f32 v106, v176, v177
  v_cvt_pk_f16_f32 v107, v178, v179
  v_cvt_pk_f16_f32 v108, v180, v181
  v_cvt_pk_f16_f32 v109, v182, v183
  v_cvt_pk_f16_f32 v110, v184, v185
  v_cvt_pk_f16_f32 v111, v186, v187
  v_cvt_pk_f16_f32 v112, v188, v189
  v_cvt_pk_f16_f32 v113, v190, v191
  v_cvt_pk_f16_f32 v114, v192, v193
  v_cvt_pk_f16_f32 v115, v194, v195
  s_setprio 3
  v_mfma_f32_32x32x16_f16 v[164:179], v[116:119], v[92:95], 0
  s_setprio 0
  v_pk_mul_f16 v50, v70, v136 op_sel:[1,0] op_sel_hi:[1,1]
  v_pk_mul_f16 v51, v70, v132 op_sel:[1,0] op_sel_hi:[1,1]
  v_pk_fma_f16 v140, v132, v70, v50 op_sel_hi:[1,0,1] neg_lo:[0,0,1] neg_hi:[0,0,1]
  v_pk_fma_f16 v144, v136, v70, v51 op_sel_hi:[1,0,1]
  v_pk_mul_f16 v50, v70, v137 op_sel:[1,0] op_sel_hi:[1,1]
  s_setprio 3
  v_mfma_f32_32x32x16_f16 v[180:195], v[120:123], v[92:95], 0
  s_setprio 0
  v_pk_mul_f16 v51, v70, v133 op_sel:[1,0] op_sel_hi:[1,1]
  v_pk_fma_f16 v141, v133, v70, v50 op_sel_hi:[1,0,1] neg_lo:[0,0,1] neg_hi:[0,0,1]
  v_pk_fma_f16 v145, v137, v70, v51 op_sel_hi:[1,0,1]
  v_pk_mul_f16 v50, v70, v138 op_sel:[1,0] op_sel_hi:[1,1]
  v_pk_mul_f16 v51, v70, v134 op_sel:[1,0] op_sel_hi:[1,1]
  v_pk_fma_f16 v142, v134, v70, v50 op_sel_hi:[1,0,1] neg_lo:[0,0,1] neg_hi:[0,0,1]
  v_pk_fma_f16 v146, v138, v70, v51 op_sel_hi:[1,0,1]
  v_pk_mul_f16 v50, v70, v139 op_sel:[1,0] op_sel_hi:[1,1]
  v_pk_mul_f16 v51, v70, v135 op_sel:[1,0] op_sel_hi:[1,1]
  v_pk_fma_f16 v143, v135, v70, v50 op_sel_hi:[1,0,1] neg_lo:[0,0,1] neg_hi:[0,0,1]
  v_pk_fma_f16 v147, v139, v70, v51 op_sel_hi:[1,0,1]
  v_pk_mul_f16 v50, v72, v136 op_sel:[1,0] op_sel_hi:[1,1]
  v_pk_mul_f16 v51, v72, v132 op_sel:[1,0] op_sel_hi:[1,1]
  v_pk_fma_f16 v148, v132, v72, v50 op_sel_hi:[1,0,1] neg_lo:[0,0,1] neg_hi:[0,0,1]
  v_pk_fma_f16 v152, v136, v72, v51 op_sel_hi:[1,0,1]
  v_pk_mul_f16 v50, v72, v137 op_sel:[1,0] op_sel_hi:[1,1]
  v_pk_mul_f16 v51, v72, v133 op_sel:[1,0] op_sel_hi:[1,1]
  v_pk_fma_f16 v149, v133, v72, v50 op_sel_hi:[1,0,1] neg_lo:[0,0,1] neg_hi:[0,0,1]
  v_pk_fma_f16 v153, v137, v72, v51 op_sel_hi:[1,0,1]
  v_cvt_pk_f16_f32 v116, v164, v165
  v_cvt_pk_f16_f32 v117, v166, v167
  v_cvt_pk_f16_f32 v118, v168, v169
  v_cvt_pk_f16_f32 v119, v170, v171
  v_cvt_pk_f16_f32 v120, v172, v173
  v_cvt_pk_f16_f32 v121, v174, v175
  v_cvt_pk_f16_f32 v122, v176, v177
  v_cvt_pk_f16_f32 v123, v178, v179
  v_cvt_pk_f16_f32 v124, v180, v181
  v_cvt_pk_f16_f32 v125, v182, v183
  v_cvt_pk_f16_f32 v126, v184, v185
  v_cvt_pk_f16_f32 v127, v186, v187
  v_cvt_pk_f16_f32 v128, v188, v189
  v_cvt_pk_f16_f32 v129, v190, v191
  v_cvt_pk_f16_f32 v130, v192, v193
  v_cvt_pk_f16_f32 v131, v194, v195
  s_setprio 3
  v_mfma_f32_32x32x16_f16 v[164:179], v[132:135], v[92:95], 0
  s_setprio 0
  v_pk_mul_f16 v50, v72, v138 op_sel:[1,0] op_sel_hi:[1,1]
  v_pk_mul_f16 v51, v72, v134 op_sel:[1,0] op_sel_hi:[1,1]
  v_pk_fma_f16 v150, v134, v72, v50 op_sel_hi:[1,0,1] neg_lo:[0,0,1] neg_hi:[0,0,1]
  v_pk_fma_f16 v154, v138, v72, v51 op_sel_hi:[1,0,1]
  v_pk_mul_f16 v50, v72, v139 op_sel:[1,0] op_sel_hi:[1,1]
  s_setprio 3
  v_mfma_f32_32x32x16_f16 v[164:179], v[140:143], v[96:99], v[164:179]
  s_setprio 0
  v_pk_mul_f16 v51, v72, v135 op_sel:[1,0] op_sel_hi:[1,1]
  v_pk_fma_f16 v151, v135, v72, v50 op_sel_hi:[1,0,1] neg_lo:[0,0,1] neg_hi:[0,0,1]
  v_pk_fma_f16 v155, v139, v72, v51 op_sel_hi:[1,0,1]
  v_pk_mul_f16 v50, v72, v144 op_sel:[1,0] op_sel_hi:[1,1]
  v_pk_mul_f16 v51, v72, v140 op_sel:[1,0] op_sel_hi:[1,1]
  s_setprio 3
  v_mfma_f32_32x32x16_f16 v[180:195], v[136:139], v[92:95], 0
  s_setprio 0
  v_pk_fma_f16 v156, v140, v72, v50 op_sel_hi:[1,0,1] neg_lo:[0,0,1] neg_hi:[0,0,1]
  v_pk_fma_f16 v160, v144, v72, v51 op_sel_hi:[1,0,1]
  v_pk_mul_f16 v50, v72, v145 op_sel:[1,0] op_sel_hi:[1,1]
  v_pk_mul_f16 v51, v72, v141 op_sel:[1,0] op_sel_hi:[1,1]
  v_pk_fma_f16 v157, v141, v72, v50 op_sel_hi:[1,0,1] neg_lo:[0,0,1] neg_hi:[0,0,1]
  s_setprio 3
  v_mfma_f32_32x32x16_f16 v[180:195], v[144:147], v[96:99], v[180:195]
  s_setprio 0
  v_pk_fma_f16 v161, v145, v72, v51 op_sel_hi:[1,0,1]
  v_pk_mul_f16 v50, v72, v146 op_sel:[1,0] op_sel_hi:[1,1]
  v_pk_mul_f16 v51, v72, v142 op_sel:[1,0] op_sel_hi:[1,1]
  v_pk_fma_f16 v158, v142, v72, v50 op_sel_hi:[1,0,1] neg_lo:[0,0,1] neg_hi:[0,0,1]
  v_pk_fma_f16 v162, v146, v72, v51 op_sel_hi:[1,0,1]
  v_pk_mul_f16 v50, v72, v147 op_sel:[1,0] op_sel_hi:[1,1]
  v_pk_mul_f16 v51, v72, v143 op_sel:[1,0] op_sel_hi:[1,1]
  v_pk_fma_f16 v159, v143, v72, v50 op_sel_hi:[1,0,1] neg_lo:[0,0,1] neg_hi:[0,0,1]
  v_pk_fma_f16 v163, v147, v72, v51 op_sel_hi:[1,0,1]
  v_cvt_pk_f16_f32 v132, v164, v165
  v_cvt_pk_f16_f32 v133, v166, v167
  v_cvt_pk_f16_f32 v134, v168, v169
  v_cvt_pk_f16_f32 v135, v170, v171
  v_cvt_pk_f16_f32 v136, v172, v173
  v_cvt_pk_f16_f32 v137, v174, v175
  v_cvt_pk_f16_f32 v138, v176, v177
  v_cvt_pk_f16_f32 v139, v178, v179
  s_setprio 3
  v_mfma_f32_32x32x16_f16 v[164:179], v[148:151], v[92:95], 0
  s_setprio 0
  v_cvt_pk_f16_f32 v140, v180, v181
  v_cvt_pk_f16_f32 v141, v182, v183
  v_cvt_pk_f16_f32 v142, v184, v185
  v_cvt_pk_f16_f32 v143, v186, v187
  s_setprio 3
  v_mfma_f32_32x32x16_f16 v[164:179], v[156:159], v[96:99], v[164:179]
  s_setprio 0
  v_cvt_pk_f16_f32 v144, v188, v189
  v_cvt_pk_f16_f32 v145, v190, v191
  v_cvt_pk_f16_f32 v146, v192, v193
  v_cvt_pk_f16_f32 v147, v194, v195
  s_setprio 3
  v_mfma_f32_32x32x16_f16 v[180:195], v[152:155], v[92:95], 0
  v_mfma_f32_32x32x16_f16 v[180:195], v[160:163], v[96:99], v[180:195]
  v_mfma_f32_16x16x32_f16 v[16:19], v[100:103], v[132:135], v[16:19]
  v_mfma_f32_16x16x32_f16 v[24:27], v[116:119], v[132:135], v[24:27]
  v_mfma_f32_16x16x32_f16 v[16:19], v[104:107], v[136:139], v[16:19]
  v_mfma_f32_16x16x32_f16 v[24:27], v[120:123], v[136:139], v[24:27]
  v_mfma_f32_16x16x32_f16 v[16:19], v[108:111], v[140:143], v[16:19]
  v_mfma_f32_16x16x32_f16 v[24:27], v[124:127], v[140:143], v[24:27]
  v_mfma_f32_16x16x32_f16 v[16:19], v[112:115], v[144:147], v[16:19]
  v_mfma_f32_16x16x32_f16 v[24:27], v[128:131], v[144:147], v[24:27]
  s_setprio 0
  v_cvt_pk_f16_f32 v148, v164, v165
  v_cvt_pk_f16_f32 v149, v166, v167
  v_cvt_pk_f16_f32 v150, v168, v169
  v_cvt_pk_f16_f32 v151, v170, v171
  v_cvt_pk_f16_f32 v152, v172, v173
  v_cvt_pk_f16_f32 v153, v174, v175
  v_cvt_pk_f16_f32 v154, v176, v177
  v_cvt_pk_f16_f32 v155, v178, v179
  s_setprio 3
  v_mfma_f32_16x16x32_f16 v[20:23], v[100:103], v[148:151], v[20:23]
  v_mfma_f32_16x16x32_f16 v[28:31], v[116:119], v[148:151], v[28:31]
  s_setprio 0
  v_cvt_pk_f16_f32 v156, v180, v181
  v_cvt_pk_f16_f32 v157, v182, v183
  v_cvt_pk_f16_f32 v158, v184, v185
  v_cvt_pk_f16_f32 v159, v186, v187
  s_setprio 3
  v_mfma_f32_16x16x32_f16 v[20:23], v[104:107], v[152:155], v[20:23]
  v_mfma_f32_16x16x32_f16 v[28:31], v[120:123], v[152:155], v[28:31]
  s_setprio 0
  v_cvt_pk_f16_f32 v160, v188, v189
  v_cvt_pk_f16_f32 v161, v190, v191
  v_cvt_pk_f16_f32 v162, v192, v193
  v_cvt_pk_f16_f32 v163, v194, v195
  s_setprio 3
  v_mfma_f32_16x16x32_f16 v[20:23], v[108:111], v[156:159], v[20:23]
  v_mfma_f32_16x16x32_f16 v[28:31], v[124:127], v[156:159], v[28:31]
  v_mfma_f32_16x16x32_f16 v[20:23], v[112:115], v[160:163], v[20:23]
  v_mfma_f32_16x16x32_f16 v[28:31], v[128:131], v[160:163], v[28:31]
  s_setprio 0
  s_setprio 3
  ds_read_b32 v3, v13 offset:1104
  ds_read_b64 v[4:5], v12 offset:0
  ds_read_b64 v[6:7], v12 offset:512
  s_waitcnt lgkmcnt(11)
  v_lshlrev_b32 v164, 16, v208
  v_and_b32 v165, 0xffff0000, v208
  v_lshlrev_b32 v166, 16, v209
  v_and_b32 v167, 0xffff0000, v209
  s_waitcnt lgkmcnt(10)
  v_lshlrev_b32 v168, 16, v210
  v_and_b32 v169, 0xffff0000, v210
  v_lshlrev_b32 v170, 16, v211
  v_and_b32 v171, 0xffff0000, v211
  s_waitcnt lgkmcnt(9)
  v_lshlrev_b32 v172, 16, v212
  v_and_b32 v173, 0xffff0000, v212
  v_lshlrev_b32 v174, 16, v213
  v_and_b32 v175, 0xffff0000, v213
  s_waitcnt lgkmcnt(8)
  v_lshlrev_b32 v176, 16, v214
  v_and_b32 v177, 0xffff0000, v214
  v_lshlrev_b32 v178, 16, v215
  v_and_b32 v179, 0xffff0000, v215
  s_waitcnt lgkmcnt(7)
  v_lshlrev_b32 v180, 16, v216
  v_and_b32 v181, 0xffff0000, v216
  v_lshlrev_b32 v182, 16, v217
  v_and_b32 v183, 0xffff0000, v217
  s_waitcnt lgkmcnt(6)
  v_lshlrev_b32 v184, 16, v218
  v_and_b32 v185, 0xffff0000, v218
  v_lshlrev_b32 v186, 16, v219
  v_and_b32 v187, 0xffff0000, v219
  s_waitcnt lgkmcnt(5)
  v_lshlrev_b32 v188, 16, v220
  v_and_b32 v189, 0xffff0000, v220
  v_lshlrev_b32 v190, 16, v221
  v_and_b32 v191, 0xffff0000, v221
  s_waitcnt lgkmcnt(4)
  v_lshlrev_b32 v192, 16, v222
  v_and_b32 v193, 0xffff0000, v222
  v_lshlrev_b32 v194, 16, v223
  v_and_b32 v195, 0xffff0000, v223
  s_waitcnt lgkmcnt(2)
  v_cmp_ne_u32 vcc, 0, v3
  s_cbranch_vccnz SL_50
BK_51:
  s_waitcnt lgkmcnt(0)
  v_add_f32 v4, v4, v6
  v_add_f32 v5, v5, v7
  v_mul_f32 v6, 0x3acccccd, v4
  v_mul_f32 v7, 0x3acccccd, v5
  v_fma_f32 v7, -v6, v6, v7
  v_max_f32 v7, 0, v7
  v_cvt_pk_bf16_f32 v8, 0, v6
  v_cvt_pk_bf16_f32 v9, 0, v7
  v_add_f32 v9, 0x3727c5ac, v9
  v_cvt_pk_bf16_f32 v9, 0, v9
  v_sqrt_f32 v9, v9
  s_nop 0
  v_cvt_pk_bf16_f32 v9, 0, v9
  v_rcp_f32 v10, v9
  v_subrev_f32_dpp v164, v8, v164 row_newbcast:0 row_mask:0xf bank_mask:0xf
  v_subrev_f32_dpp v165, v8, v165 row_newbcast:1 row_mask:0xf bank_mask:0xf
  v_subrev_f32_dpp v166, v8, v166 row_newbcast:2 row_mask:0xf bank_mask:0xf
  v_subrev_f32_dpp v167, v8, v167 row_newbcast:3 row_mask:0xf bank_mask:0xf
  v_subrev_f32_dpp v168, v8, v168 row_newbcast:4 row_mask:0xf bank_mask:0xf
  v_subrev_f32_dpp v169, v8, v169 row_newbcast:5 row_mask:0xf bank_mask:0xf
  v_subrev_f32_dpp v170, v8, v170 row_newbcast:6 row_mask:0xf bank_mask:0xf
  v_subrev_f32_dpp v171, v8, v171 row_newbcast:7 row_mask:0xf bank_mask:0xf
  v_mul_f32_dpp v164, v10, v164 row_newbcast:0 row_mask:0xf bank_mask:0xf
  v_mul_f32_dpp v165, v10, v165 row_newbcast:1 row_mask:0xf bank_mask:0xf
  v_mul_f32_dpp v166, v10, v166 row_newbcast:2 row_mask:0xf bank_mask:0xf
  v_mul_f32_dpp v167, v10, v167 row_newbcast:3 row_mask:0xf bank_mask:0xf
  v_mul_f32_dpp v168, v10, v168 row_newbcast:4 row_mask:0xf bank_mask:0xf
  v_mul_f32_dpp v169, v10, v169 row_newbcast:5 row_mask:0xf bank_mask:0xf
  v_mul_f32_dpp v170, v10, v170 row_newbcast:6 row_mask:0xf bank_mask:0xf
  v_mul_f32_dpp v171, v10, v171 row_newbcast:7 row_mask:0xf bank_mask:0xf
  v_cvt_pk_bf16_f32 v208, v164, v165
  v_cvt_pk_bf16_f32 v209, v166, v167
  v_cvt_pk_bf16_f32 v210, v168, v169
  v_cvt_pk_bf16_f32 v211, v170, v171
  buffer_store_dwordx4 v[208:211], v14, s[48:51], s78 offen offset:0 sc1
  v_subrev_f32_dpp v172, v8, v172 row_newbcast:8 row_mask:0xf bank_mask:0xf
  v_subrev_f32_dpp v173, v8, v173 row_newbcast:9 row_mask:0xf bank_mask:0xf
  v_subrev_f32_dpp v174, v8, v174 row_newbcast:10 row_mask:0xf bank_mask:0xf
  v_subrev_f32_dpp v175, v8, v175 row_newbcast:11 row_mask:0xf bank_mask:0xf
  v_subrev_f32_dpp v176, v8, v176 row_newbcast:12 row_mask:0xf bank_mask:0xf
  v_subrev_f32_dpp v177, v8, v177 row_newbcast:13 row_mask:0xf bank_mask:0xf
  v_subrev_f32_dpp v178, v8, v178 row_newbcast:14 row_mask:0xf bank_mask:0xf
  v_subrev_f32_dpp v179, v8, v179 row_newbcast:15 row_mask:0xf bank_mask:0xf
  v_mul_f32_dpp v172, v10, v172 row_newbcast:8 row_mask:0xf bank_mask:0xf
  v_mul_f32_dpp v173, v10, v173 row_newbcast:9 row_mask:0xf bank_mask:0xf
  v_mul_f32_dpp v174, v10, v174 row_newbcast:10 row_mask:0xf bank_mask:0xf
  v_mul_f32_dpp v175, v10, v175 row_newbcast:11 row_mask:0xf bank_mask:0xf
  v_mul_f32_dpp v176, v10, v176 row_newbcast:12 row_mask:0xf bank_mask:0xf
  v_mul_f32_dpp v177, v10, v177 row_newbcast:13 row_mask:0xf bank_mask:0xf
  v_mul_f32_dpp v178, v10, v178 row_newbcast:14 row_mask:0xf bank_mask:0xf
  v_mul_f32_dpp v179, v10, v179 row_newbcast:15 row_mask:0xf bank_mask:0xf
  v_cvt_pk_bf16_f32 v212, v172, v173
  v_cvt_pk_bf16_f32 v213, v174, v175
  v_cvt_pk_bf16_f32 v214, v176, v177
  v_cvt_pk_bf16_f32 v215, v178, v179
  buffer_store_dwordx4 v[212:215], v14, s[48:51], s78 offen offset:64 sc1
  v_subrev_f32_dpp v180, v8, v180 row_newbcast:0 row_mask:0xf bank_mask:0xf
  v_subrev_f32_dpp v181, v8, v181 row_newbcast:1 row_mask:0xf bank_mask:0xf
  v_subrev_f32_dpp v182, v8, v182 row_newbcast:2 row_mask:0xf bank_mask:0xf
  v_subrev_f32_dpp v183, v8, v183 row_newbcast:3 row_mask:0xf bank_mask:0xf
  v_subrev_f32_dpp v184, v8, v184 row_newbcast:4 row_mask:0xf bank_mask:0xf
  v_subrev_f32_dpp v185, v8, v185 row_newbcast:5 row_mask:0xf bank_mask:0xf
  v_subrev_f32_dpp v186, v8, v186 row_newbcast:6 row_mask:0xf bank_mask:0xf
  v_subrev_f32_dpp v187, v8, v187 row_newbcast:7 row_mask:0xf bank_mask:0xf
  v_mul_f32_dpp v180, v10, v180 row_newbcast:0 row_mask:0xf bank_mask:0xf
  v_mul_f32_dpp v181, v10, v181 row_newbcast:1 row_mask:0xf bank_mask:0xf
  v_mul_f32_dpp v182, v10, v182 row_newbcast:2 row_mask:0xf bank_mask:0xf
  v_mul_f32_dpp v183, v10, v183 row_newbcast:3 row_mask:0xf bank_mask:0xf
  v_mul_f32_dpp v184, v10, v184 row_newbcast:4 row_mask:0xf bank_mask:0xf
  v_mul_f32_dpp v185, v10, v185 row_newbcast:5 row_mask:0xf bank_mask:0xf
  v_mul_f32_dpp v186, v10, v186 row_newbcast:6 row_mask:0xf bank_mask:0xf
  v_mul_f32_dpp v187, v10, v187 row_newbcast:7 row_mask:0xf bank_mask:0xf
  v_cvt_pk_bf16_f32 v216, v180, v181
  v_cvt_pk_bf16_f32 v217, v182, v183
  v_cvt_pk_bf16_f32 v218, v184, v185
  v_cvt_pk_bf16_f32 v219, v186, v187
  buffer_store_dwordx4 v[216:219], v14, s[48:51], s79 offen offset:0 sc1
  v_subrev_f32_dpp v188, v8, v188 row_newbcast:8 row_mask:0xf bank_mask:0xf
  v_subrev_f32_dpp v189, v8, v189 row_newbcast:9 row_mask:0xf bank_mask:0xf
  v_subrev_f32_dpp v190, v8, v190 row_newbcast:10 row_mask:0xf bank_mask:0xf
  v_subrev_f32_dpp v191, v8, v191 row_newbcast:11 row_mask:0xf bank_mask:0xf
  v_subrev_f32_dpp v192, v8, v192 row_newbcast:12 row_mask:0xf bank_mask:0xf
  v_subrev_f32_dpp v193, v8, v193 row_newbcast:13 row_mask:0xf bank_mask:0xf
  v_subrev_f32_dpp v194, v8, v194 row_newbcast:14 row_mask:0xf bank_mask:0xf
  v_subrev_f32_dpp v195, v8, v195 row_newbcast:15 row_mask:0xf bank_mask:0xf
  v_mul_f32_dpp v188, v10, v188 row_newbcast:8 row_mask:0xf bank_mask:0xf
  v_mul_f32_dpp v189, v10, v189 row_newbcast:9 row_mask:0xf bank_mask:0xf
  v_mul_f32_dpp v190, v10, v190 row_newbcast:10 row_mask:0xf bank_mask:0xf
  v_mul_f32_dpp v191, v10, v191 row_newbcast:11 row_mask:0xf bank_mask:0xf
  v_mul_f32_dpp v192, v10, v192 row_newbcast:12 row_mask:0xf bank_mask:0xf
  v_mul_f32_dpp v193, v10, v193 row_newbcast:13 row_mask:0xf bank_mask:0xf
  v_mul_f32_dpp v194, v10, v194 row_newbcast:14 row_mask:0xf bank_mask:0xf
  v_mul_f32_dpp v195, v10, v195 row_newbcast:15 row_mask:0xf bank_mask:0xf
  v_cvt_pk_bf16_f32 v220, v188, v189
  v_cvt_pk_bf16_f32 v221, v190, v191
  v_cvt_pk_bf16_f32 v222, v192, v193
  v_cvt_pk_bf16_f32 v223, v194, v195
  buffer_store_dwordx4 v[220:223], v14, s[48:51], s79 offen offset:64 sc1
  v_and_b32 v225, 7, v0
  v_lshlrev_b32 v225, 2, v225
  global_load_dword v224, v225, s[42:43] sc1
  s_setprio 0
  v_pk_mul_f16 v50, v89, v82 op_sel:[1,1] op_sel_hi:[0,1]
  v_pk_fma_f16 v52, v89, v82, v50 op_sel_hi:[1,0,1] neg_hi:[0,0,1]
  v_perm_b32 v124, v52, v89, s72
  v_perm_b32 v128, v52, v89, s73
  v_pk_mul_f16 v50, v76, v128 op_sel:[1,0] op_sel_hi:[1,1]
  v_pk_mul_f16 v51, v76, v124 op_sel:[1,0] op_sel_hi:[1,1]
  v_pk_fma_f16 v100, v124, v76, v50 op_sel_hi:[1,0,1]
  v_pk_fma_f16 v104, v128, v76, v51 op_sel_hi:[1,0,1] neg_lo:[0,0,1] neg_hi:[0,0,1]
  v_pk_mul_f16 v50, v77, v128 op_sel:[1,0] op_sel_hi:[1,1]
  v_pk_mul_f16 v51, v77, v124 op_sel:[1,0] op_sel_hi:[1,1]
  v_pk_fma_f16 v101, v124, v77, v50 op_sel_hi:[1,0,1]
  v_pk_fma_f16 v105, v128, v77, v51 op_sel_hi:[1,0,1] neg_lo:[0,0,1] neg_hi:[0,0,1]
  v_pk_mul_f16 v50, v77, v104 op_sel:[1,0] op_sel_hi:[1,1]
  v_pk_mul_f16 v51, v77, v100 op_sel:[1,0] op_sel_hi:[1,1]
  v_pk_fma_f16 v102, v100, v77, v50 op_sel_hi:[1,0,1]
  v_pk_fma_f16 v106, v104, v77, v51 op_sel_hi:[1,0,1] neg_lo:[0,0,1] neg_hi:[0,0,1]
  v_pk_mul_f16 v50, v78, v128 op_sel:[1,0] op_sel_hi:[1,1]
  v_pk_mul_f16 v51, v78, v124 op_sel:[1,0] op_sel_hi:[1,1]
  v_pk_fma_f16 v103, v124, v78, v50 op_sel_hi:[1,0,1]
  v_pk_fma_f16 v107, v128, v78, v51 op_sel_hi:[1,0,1] neg_lo:[0,0,1] neg_hi:[0,0,1]
  v_pk_mul_f16 v50, v84, v105 op_sel:[1,0] op_sel_hi:[1,1]
  v_pk_mul_f16 v51, v84, v101 op_sel:[1,0] op_sel_hi:[1,1]
  v_pk_fma_f16 v108, v101, v84, v50 op_sel_hi:[1,0,1]
  v_pk_fma_f16 v112, v105, v84, v51 op_sel_hi:[1,0,1] neg_lo:[0,0,1] neg_hi:[0,0,1]
  v_pk_mul_f16 v50, v84, v107 op_sel:[1,0] op_sel_hi:[1,1]
  v_pk_mul_f16 v51, v84, v103 op_sel:[1,0] op_sel_hi:[1,1]
  v_pk_fma_f16 v109, v103, v84, v50 op_sel_hi:[1,0,1]
  v_pk_fma_f16 v113, v107, v84, v51 op_sel_hi:[1,0,1] neg_lo:[0,0,1] neg_hi:[0,0,1]
  v_pk_mul_f16 v50, v85, v107 op_sel:[1,0] op_sel_hi:[1,1]
  v_pk_mul_f16 v51, v85, v103 op_sel:[1,0] op_sel_hi:[1,1]
  v_pk_fma_f16 v110, v103, v85, v50 op_sel_hi:[1,0,1]
  v_pk_fma_f16 v114, v107, v85, v51 op_sel_hi:[1,0,1] neg_lo:[0,0,1] neg_hi:[0,0,1]
  v_pk_mul_f16 v50, v85, v113 op_sel:[1,0] op_sel_hi:[1,1]
  v_pk_mul_f16 v51, v85, v109 op_sel:[1,0] op_sel_hi:[1,1]
  v_pk_fma_f16 v111, v109, v85, v50 op_sel_hi:[1,0,1]
  v_pk_fma_f16 v115, v113, v85, v51 op_sel_hi:[1,0,1] neg_lo:[0,0,1] neg_hi:[0,0,1]
  s_setprio 3
  v_mfma_f32_32x32x16_f16 v[164:179], v[100:103], v[92:95], 0
  s_setprio 0
  v_pk_mul_f16 v50, v86, v107 op_sel:[1,0] op_sel_hi:[1,1]
  v_pk_mul_f16 v51, v86, v103 op_sel:[1,0] op_sel_hi:[1,1]
  v_pk_fma_f16 v116, v103, v86, v50 op_sel_hi:[1,0,1]
  v_pk_fma_f16 v120, v107, v86, v51 op_sel_hi:[1,0,1] neg_lo:[0,0,1] neg_hi:[0,0,1]
  v_pk_mul_f16 v50, v86, v113 op_sel:[1,0] op_sel_hi:[1,1]
  s_setprio 3
  v_mfma_f32_32x32x16_f16 v[164:179], v[108:111], v[96:99], v[164:179]
  s_setprio 0
  v_pk_mul_f16 v51, v86, v109 op_sel:[1,0] op_sel_hi:[1,1]
  v_pk_fma_f16 v117, v109, v86, v50 op_sel_hi:[1,0,1]
  v_pk_fma_f16 v121, v113, v86, v51 op_sel_hi:[1,0,1] neg_lo:[0,0,1] neg_hi:[0,0,1]
  v_pk_mul_f16 v50, v86, v114 op_sel:[1,0] op_sel_hi:[1,1]
  v_pk_mul_f16 v51, v86, v110 op_sel:[1,0] op_sel_hi:[1,1]
  s_setprio 3
  v_mfma_f32_32x32x16_f16 v[180:195], v[104:107], v[92:95], 0
  s_setprio 0
  v_pk_fma_f16 v118, v110, v86, v50 op_sel_hi:[1,0,1]
  v_pk_fma_f16 v122, v114, v86, v51 op_sel_hi:[1,0,1] neg_lo:[0,0,1] neg_hi:[0,0,1]
  v_pk_mul_f16 v50, v86, v115 op_sel:[1,0] op_sel_hi:[1,1]
  v_pk_mul_f16 v51, v86, v111 op_sel:[1,0] op_sel_hi:[1,1]
  v_pk_fma_f16 v119, v111, v86, v50 op_sel_hi:[1,0,1]
  s_setprio 3
  v_mfma_f32_32x32x16_f16 v[180:195], v[112:115], v[96:99], v[180:195]
  s_setprio 0
  v_pk_fma_f16 v123, v115, v86, v51 op_sel_hi:[1,0,1] neg_lo:[0,0,1] neg_hi:[0,0,1]
  v_lshl_or_b32 v132, v80, 16, v46
  v_and_b32 v136, 0xffff0000, v80
  v_pk_mul_f16 v50, v78, v136 op_sel:[1,0] op_sel_hi:[1,1]
  v_pk_mul_f16 v51, v78, v132 op_sel:[1,0] op_sel_hi:[1,1]
  v_pk_fma_f16 v133, v132, v78, v50 op_sel_hi:[1,0,1] neg_lo:[0,0,1] neg_hi:[0,0,1]
  v_pk_fma_f16 v137, v136, v78, v51 op_sel_hi:[1,0,1]
  v_pk_mul_f16 v50, v79, v136 op_sel:[1,0] op_sel_hi:[1,1]
  v_pk_mul_f16 v51, v79, v132 op_sel:[1,0] op_sel_hi:[1,1]
  v_pk_fma_f16 v134, v132, v79, v50 op_sel_hi:[1,0,1] neg_lo:[0,0,1] neg_hi:[0,0,1]
  v_pk_fma_f16 v138, v136, v79, v51 op_sel_hi:[1,0,1]
  v_pk_mul_f16 v50, v79, v137 op_sel:[1,0] op_sel_hi:[1,1]
  v_pk_mul_f16 v51, v79, v133 op_sel:[1,0] op_sel_hi:[1,1]
  v_pk_fma_f16 v135, v133, v79, v50 op_sel_hi:[1,0,1] neg_lo:[0,0,1] neg_hi:[0,0,1]
  v_pk_fma_f16 v139, v137, v79, v51 op_sel_hi:[1,0,1]
  v_cvt_pk_f16_f32 v100, v164, v165
  v_cvt_pk_f16_f32 v101, v166, v167
  v_cvt_pk_f16_f32 v102, v168, v169
  v_cvt_pk_f16_f32 v103, v170, v171
  v_cvt_pk_f16_f32 v104, v172, v173
  v_cvt_pk_f16_f32 v105, v174, v175
  v_cvt_pk_f16_f32 v106, v176, v177
  v_cvt_pk_f16_f32 v107, v178, v179
  v_cvt_pk_f16_f32 v108, v180, v181
  v_cvt_pk_f16_f32 v109, v182, v183
  v_cvt_pk_f16_f32 v110, v184, v185
  v_cvt_pk_f16_f32 v111, v186, v187
  v_cvt_pk_f16_f32 v112, v188, v189
  v_cvt_pk_f16_f32 v113, v190, v191
  v_cvt_pk_f16_f32 v114, v192, v193
  v_cvt_pk_f16_f32 v115, v194, v195
  s_setprio 3
  s_waitcnt vmcnt(1)
  s_waitcnt vmcnt(0)
  v_cmp_eq_u32 vcc, 0, v224
  s_cbranch_vccnz SL_46
BK_47:
  v_mov_b32 v224, 1
  v_lshlrev_b32 v225, 7, v0
  s_mov_b64 exec, 255
  buffer_atomic_add v224, v225, s[48:51], s13 offen sc1
  s_mov_b64 exec, -1
  s_setprio 0
  s_mul_i32 s74, s5, 3072
  s_lshr_b32 s64, s4, 2
  s_lshl_b32 s64, s64, 7
  s_add_u32 s74, s74, s64
  s_add_u32 s74, s74, 16793600
  s_setprio 3
  v_mfma_f32_32x32x16_f16 v[164:179], v[116:119], v[92:95], 0
  s_setprio 0
  v_pk_mul_f16 v50, v81, v136 op_sel:[1,0] op_sel_hi:[1,1]
  v_pk_mul_f16 v51, v81, v132 op_sel:[1,0] op_sel_hi:[1,1]
  v_pk_fma_f16 v140, v132, v81, v50 op_sel_hi:[1,0,1] neg_lo:[0,0,1] neg_hi:[0,0,1]
  v_pk_fma_f16 v144, v136, v81, v51 op_sel_hi:[1,0,1]
  v_pk_mul_f16 v50, v81, v137 op_sel:[1,0] op_sel_hi:[1,1]
  s_setprio 3
  v_mfma_f32_32x32x16_f16 v[180:195], v[120:123], v[92:95], 0
  s_setprio 0
  v_pk_mul_f16 v51, v81, v133 op_sel:[1,0] op_sel_hi:[1,1]
  v_pk_fma_f16 v141, v133, v81, v50 op_sel_hi:[1,0,1] neg_lo:[0,0,1] neg_hi:[0,0,1]
  v_pk_fma_f16 v145, v137, v81, v51 op_sel_hi:[1,0,1]
  v_pk_mul_f16 v50, v81, v138 op_sel:[1,0] op_sel_hi:[1,1]
  v_pk_mul_f16 v51, v81, v134 op_sel:[1,0] op_sel_hi:[1,1]
  v_pk_fma_f16 v142, v134, v81, v50 op_sel_hi:[1,0,1] neg_lo:[0,0,1] neg_hi:[0,0,1]
  v_pk_fma_f16 v146, v138, v81, v51 op_sel_hi:[1,0,1]
  v_pk_mul_f16 v50, v81, v139 op_sel:[1,0] op_sel_hi:[1,1]
  v_pk_mul_f16 v51, v81, v135 op_sel:[1,0] op_sel_hi:[1,1]
  v_pk_fma_f16 v143, v135, v81, v50 op_sel_hi:[1,0,1] neg_lo:[0,0,1] neg_hi:[0,0,1]
  v_pk_fma_f16 v147, v139, v81, v51 op_sel_hi:[1,0,1]
  v_pk_mul_f16 v50, v83, v136 op_sel:[1,0] op_sel_hi:[1,1]
  v_pk_mul_f16 v51, v83, v132 op_sel:[1,0] op_sel_hi:[1,1]
  v_pk_fma_f16 v148, v132, v83, v50 op_sel_hi:[1,0,1] neg_lo:[0,0,1] neg_hi:[0,0,1]
  v_pk_fma_f16 v152, v136, v83, v51 op_sel_hi:[1,0,1]
  v_pk_mul_f16 v50, v83, v137 op_sel:[1,0] op_sel_hi:[1,1]
  v_pk_mul_f16 v51, v83, v133 op_sel:[1,0] op_sel_hi:[1,1]
  v_pk_fma_f16 v149, v133, v83, v50 op_sel_hi:[1,0,1] neg_lo:[0,0,1] neg_hi:[0,0,1]
  v_pk_fma_f16 v153, v137, v83, v51 op_sel_hi:[1,0,1]
  v_cvt_pk_f16_f32 v116, v164, v165
  v_cvt_pk_f16_f32 v117, v166, v167
  v_cvt_pk_f16_f32 v118, v168, v169
  v_cvt_pk_f16_f32 v119, v170, v171
  v_cvt_pk_f16_f32 v120, v172, v173
  v_cvt_pk_f16_f32 v121, v174, v175
  v_cvt_pk_f16_f32 v122, v176, v177
  v_cvt_pk_f16_f32 v123, v178, v179
  v_cvt_pk_f16_f32 v124, v180, v181
  v_cvt_pk_f16_f32 v125, v182, v183
  v_cvt_pk_f16_f32 v126, v184, v185
  v_cvt_pk_f16_f32 v127, v186, v187
  v_cvt_pk_f16_f32 v128, v188, v189
  v_cvt_pk_f16_f32 v129, v190, v191
  v_cvt_pk_f16_f32 v130, v192, v193
  v_cvt_pk_f16_f32 v131, v194, v195
  s_setprio 3
  v_mfma_f32_32x32x16_f16 v[164:179], v[132:135], v[92:95], 0
  s_setprio 0
  v_pk_mul_f16 v50, v83, v138 op_sel:[1,0] op_sel_hi:[1,1]
  v_pk_mul_f16 v51, v83, v134 op_sel:[1,0] op_sel_hi:[1,1]
  v_pk_fma_f16 v150, v134, v83, v50 op_sel_hi:[1,0,1] neg_lo:[0,0,1] neg_hi:[0,0,1]
  v_pk_fma_f16 v154, v138, v83, v51 op_sel_hi:[1,0,1]
  v_pk_mul_f16 v50, v83, v139 op_sel:[1,0] op_sel_hi:[1,1]
  s_setprio 3
  v_mfma_f32_32x32x16_f16 v[164:179], v[140:143], v[96:99], v[164:179]
  s_setprio 0
  v_pk_mul_f16 v51, v83, v135 op_sel:[1,0] op_sel_hi:[1,1]
  v_pk_fma_f16 v151, v135, v83, v50 op_sel_hi:[1,0,1] neg_lo:[0,0,1] neg_hi:[0,0,1]
  v_pk_fma_f16 v155, v139, v83, v51 op_sel_hi:[1,0,1]
  v_pk_mul_f16 v50, v83, v144 op_sel:[1,0] op_sel_hi:[1,1]
  v_pk_mul_f16 v51, v83, v140 op_sel:[1,0] op_sel_hi:[1,1]
  s_setprio 3
  v_mfma_f32_32x32x16_f16 v[180:195], v[136:139], v[92:95], 0
  s_setprio 0
  v_pk_fma_f16 v156, v140, v83, v50 op_sel_hi:[1,0,1] neg_lo:[0,0,1] neg_hi:[0,0,1]
  v_pk_fma_f16 v160, v144, v83, v51 op_sel_hi:[1,0,1]
  v_pk_mul_f16 v50, v83, v145 op_sel:[1,0] op_sel_hi:[1,1]
  v_pk_mul_f16 v51, v83, v141 op_sel:[1,0] op_sel_hi:[1,1]
  v_pk_fma_f16 v157, v141, v83, v50 op_sel_hi:[1,0,1] neg_lo:[0,0,1] neg_hi:[0,0,1]
  s_setprio 3
  v_mfma_f32_32x32x16_f16 v[180:195], v[144:147], v[96:99], v[180:195]
  s_setprio 0
  v_pk_fma_f16 v161, v145, v83, v51 op_sel_hi:[1,0,1]
  v_pk_mul_f16 v50, v83, v146 op_sel:[1,0] op_sel_hi:[1,1]
  v_pk_mul_f16 v51, v83, v142 op_sel:[1,0] op_sel_hi:[1,1]
  v_pk_fma_f16 v158, v142, v83, v50 op_sel_hi:[1,0,1] neg_lo:[0,0,1] neg_hi:[0,0,1]
  v_pk_fma_f16 v162, v146, v83, v51 op_sel_hi:[1,0,1]
  v_pk_mul_f16 v50, v83, v147 op_sel:[1,0] op_sel_hi:[1,1]
  v_pk_mul_f16 v51, v83, v143 op_sel:[1,0] op_sel_hi:[1,1]
  v_pk_fma_f16 v159, v143, v83, v50 op_sel_hi:[1,0,1] neg_lo:[0,0,1] neg_hi:[0,0,1]
  v_pk_fma_f16 v163, v147, v83, v51 op_sel_hi:[1,0,1]
  v_cvt_pk_f16_f32 v132, v164, v165
  v_cvt_pk_f16_f32 v133, v166, v167
  v_cvt_pk_f16_f32 v134, v168, v169
  v_cvt_pk_f16_f32 v135, v170, v171
  v_cvt_pk_f16_f32 v136, v172, v173
  v_cvt_pk_f16_f32 v137, v174, v175
  v_cvt_pk_f16_f32 v138, v176, v177
  v_cvt_pk_f16_f32 v139, v178, v179
  s_setprio 3
  v_mfma_f32_32x32x16_f16 v[164:179], v[148:151], v[92:95], 0
  s_setprio 0
  v_cvt_pk_f16_f32 v140, v180, v181
  v_cvt_pk_f16_f32 v141, v182, v183
  v_cvt_pk_f16_f32 v142, v184, v185
  v_cvt_pk_f16_f32 v143, v186, v187
  s_setprio 3
  v_mfma_f32_32x32x16_f16 v[164:179], v[156:159], v[96:99], v[164:179]
  s_setprio 0
  v_cvt_pk_f16_f32 v144, v188, v189
  v_cvt_pk_f16_f32 v145, v190, v191
  v_cvt_pk_f16_f32 v146, v192, v193
  v_cvt_pk_f16_f32 v147, v194, v195
  s_setprio 3
  v_mfma_f32_32x32x16_f16 v[180:195], v[152:155], v[92:95], 0
  v_mfma_f32_32x32x16_f16 v[180:195], v[160:163], v[96:99], v[180:195]
  v_mfma_f32_16x16x32_f16 v[16:19], v[100:103], v[132:135], v[16:19]
  v_mfma_f32_16x16x32_f16 v[24:27], v[116:119], v[132:135], v[24:27]
  v_mfma_f32_16x16x32_f16 v[16:19], v[104:107], v[136:139], v[16:19]
  v_mfma_f32_16x16x32_f16 v[24:27], v[120:123], v[136:139], v[24:27]
  v_mfma_f32_16x16x32_f16 v[16:19], v[108:111], v[140:143], v[16:19]
  v_mfma_f32_16x16x32_f16 v[24:27], v[124:127], v[140:143], v[24:27]
  v_mfma_f32_16x16x32_f16 v[16:19], v[112:115], v[144:147], v[16:19]
  v_mfma_f32_16x16x32_f16 v[24:27], v[128:131], v[144:147], v[24:27]
  s_setprio 0
  v_cvt_pk_f16_f32 v148, v164, v165
  v_cvt_pk_f16_f32 v149, v166, v167
  v_cvt_pk_f16_f32 v150, v168, v169
  v_cvt_pk_f16_f32 v151, v170, v171
  v_cvt_pk_f16_f32 v152, v172, v173
  v_cvt_pk_f16_f32 v153, v174, v175
  v_cvt_pk_f16_f32 v154, v176, v177
  v_cvt_pk_f16_f32 v155, v178, v179
  s_setprio 3
  v_mfma_f32_16x16x32_f16 v[20:23], v[100:103], v[148:151], v[20:23]
  v_mfma_f32_16x16x32_f16 v[28:31], v[116:119], v[148:151], v[28:31]
  s_setprio 0
  v_cvt_pk_f16_f32 v156, v180, v181
  v_cvt_pk_f16_f32 v157, v182, v183
  v_cvt_pk_f16_f32 v158, v184, v185
  v_cvt_pk_f16_f32 v159, v186, v187
  s_setprio 3
  v_mfma_f32_16x16x32_f16 v[20:23], v[104:107], v[152:155], v[20:23]
  v_mfma_f32_16x16x32_f16 v[28:31], v[120:123], v[152:155], v[28:31]
  s_setprio 0
  v_cvt_pk_f16_f32 v160, v188, v189
  v_cvt_pk_f16_f32 v161, v190, v191
  v_cvt_pk_f16_f32 v162, v192, v193
  v_cvt_pk_f16_f32 v163, v194, v195
  s_setprio 3
  v_mfma_f32_16x16x32_f16 v[20:23], v[108:111], v[156:159], v[20:23]
  v_mfma_f32_16x16x32_f16 v[28:31], v[124:127], v[156:159], v[28:31]
  v_mfma_f32_16x16x32_f16 v[20:23], v[112:115], v[160:163], v[20:23]
  v_mfma_f32_16x16x32_f16 v[28:31], v[128:131], v[160:163], v[28:31]
  s_setprio 0
  s_setprio 3
  v_lshlrev_b32 v15, 10, v0
  v_mov_b32 v14, 0
  s_mov_b64 exec, 7
  buffer_atomic_add v14, v15, s[48:51], s74 offen sc0 sc1
  s_mov_b64 exec, -1
  s_setprio 0
  v_mul_f32 v44, s71, v44
  v_permlane32_swap_b32 v16, v20
  v_permlane32_swap_b32 v17, v21
  v_permlane32_swap_b32 v18, v22
  v_permlane32_swap_b32 v19, v23
  v_permlane32_swap_b32 v24, v28
  v_permlane32_swap_b32 v25, v29
  v_permlane32_swap_b32 v26, v30
  v_permlane32_swap_b32 v27, v31
  v_mul_f32 v16, v44, v16
  v_mul_f32 v17, v44, v17
  v_mul_f32 v18, v44, v18
  v_mul_f32 v19, v44, v19
  v_mul_f32 v20, v44, v20
  v_mul_f32 v21, v44, v21
  v_mul_f32 v22, v44, v22
  v_mul_f32 v23, v44, v23
  v_mul_f32 v24, v44, v24
  v_mul_f32 v25, v44, v25
  v_mul_f32 v26, v44, v26
  v_mul_f32 v27, v44, v27
  v_fma_f32 v45, v45, v44, s68
  v_mov_b32 v2, v45
  v_cvt_pk_bf16_f32 v177, v45, 0
  v_mov_b32 v179, 0
  v_cvt_pk_bf16_f32 v172, v19, v18
  v_cvt_pk_bf16_f32 v174, v18, v17
  v_mov_b32_dpp v2, v19 wave_shr:1 row_mask:0xf bank_mask:0xf
  v_cvt_pk_bf16_f32 v173, v17, v16
  v_cvt_pk_bf16_f32 v176, v17, v16
  v_readlane_b32 s66, v177, 0
  v_cvt_pk_bf16_f32 v175, v16, v2
  v_cvt_pk_bf16_f32 v178, v16, v2
  v_mov_b32_dpp v177, v172 wave_shr:1 row_mask:0xf bank_mask:0xf
  v_mov_b32_dpp v179, v174 wave_shr:1 row_mask:0xf bank_mask:0xf
  v_readlane_b32 s63, v19, 63
  v_readlane_b32 s64, v172, 63
  v_readlane_b32 s65, v174, 63
  v_cvt_pk_bf16_f32 v180, v21, v21
  v_cvt_pk_bf16_f32 v182, v21, v20
  v_mov_b32 v2, s63
  v_mov_b32 v185, s64
  v_mov_b32 v187, s65
  v_cvt_pk_bf16_f32 v188, v22, v23
  v_mov_b32_dpp v2, v21 wave_shr:1 row_mask:0xf bank_mask:0xf
  v_mov_b32_dpp v185, v180 wave_shr:1 row_mask:0xf bank_mask:0xf
  v_mov_b32_dpp v187, v182 wave_shr:1 row_mask:0xf bank_mask:0xf
  v_cvt_pk_bf16_f32 v181, v20, v2
  v_cvt_pk_bf16_f32 v184, v20, v2
  v_cvt_pk_bf16_f32 v183, v2, v2
  v_cvt_pk_bf16_f32 v186, v2, v2
  v_readlane_b32 s63, v180, 63
  v_readlane_b32 s64, v182, 63
  v_cvt_pk_bf16_f32 v189, v24, v26
  v_cvt_pk_bf16_f32 v8, v25, v27
  v_mov_b32 v4, s63
  v_mov_b32 v5, s63
  v_max_u32 v3, 1, v0
  v_lshl_add_u32 v3, v3, 4, -16
  v_lshlrev_b64 v[190:191], v3, v[4:5]
  v_add_u32 v3, 1, v0
  v_and_b32 v4, 3, v3
  v_mul_u32_u24 v4, 1346, v4
  v_lshlrev_b32 v3, 1, v3
  v_sub_u32 v4, v4, v3
  v_add3_u32 v192, v4, s61, 56
  s_add_u32 s65, s61, 1080
  v_writelane_b32 v191, s64, 0
  v_writelane_b32 v190, s66, 5
  v_writelane_b32 v191, 0, 5
  v_writelane_b32 v192, s65, 5
  v_and_b32 v3, 1, v0
  v_cmp_eq_u32 vcc, 1, v3
  v_lshlrev_b32 v3, 6, v3
  v_and_b32 v4, 62, v0
  v_sub_u32 v3, v4, v3
  v_cndmask_b32_dpp v189, v8, v189, vcc quad_perm:[1,1,3,3] row_mask:0xf bank_mask:0xf
  v_add_u32 v195, s61, v3
  v_lshlrev_b32 v3, 3, v0
  v_sub_u32 v193, s61, v3
  v_lshl_add_u32 v194, v0, 1, s61
  v_mov_b32 v196, s47
  v_and_b32 v2, 3, v0
  v_and_b32 v3, 12, v0
  v_lshrrev_b32 v4, 4, v0
  v_mul_u32_u24 v5, 1344, v2
  v_lshl_add_u32 v6, v4, 3, v3
  v_lshlrev_b32 v6, 1, v6
  v_sub_u32 v5, v5, v6
  v_add_u32 v197, s61, v5
  v_mul_u32_u24 v7, 448, v2
  v_sub_u32 v7, v7, v6
  v_add_u32 v7, 39168, v7
  ds_read_b64 v[228:229], v7 offset:80
  ds_read_b64 v[230:231], v7 offset:88
  ds_read_b64 v[232:233], v7 offset:168
  ds_read_b64 v[234:235], v7 offset:176
  ds_read_b64 v[236:237], v7 offset:96
  ds_read_b64 v[238:239], v7 offset:104
  ds_read_b64 v[240:241], v7 offset:248
  ds_read_b64 v[242:243], v7 offset:256
  ds_read_b64 v[244:245], v7 offset:328
  ds_read_b64 v[246:247], v7 offset:336
  ds_read_b64 v[252:253], v7 offset:392
  ds_read_b64 v[254:255], v7 offset:400
  v_and_b32 v5, 15, v0
  v_lshlrev_b32 v6, 2, v4
  v_sub_u32 v5, v5, v6
  v_lshl_add_u32 v198, v5, 3, s61
  v_lshl_add_u32 v199, v5, 2, s61
  v_readlane_b32 s63, v188, 63
  s_pack_hh_b32_b16 s63, s63, s63
  s_waitcnt lgkmcnt(1)
  v_and_b32 v252, s63, v252
  v_and_b32 v253, s63, v253
  s_waitcnt lgkmcnt(0)
  v_and_b32 v254, s63, v254
  v_and_b32 v255, s63, v255
  v_and_b32 v4, 15, v0
  v_lshrrev_b32 v5, 4, v0
  v_lshlrev_b32 v6, 5, v4
  v_lshlrev_b32 v7, 4, v5
  v_sub_u32 v6, v6, v7
  s_mul_i32 s63, s60, 4608
  s_add_u32 s63, s63, 1600
  v_add_u32 v6, s63, v6
  v_and_b32 v7, 1, v5
  v_lshlrev_b32 v7, 9, v7
  v_lshrrev_b32 v8, 2, v4
  v_lshl_add_u32 v7, v8, 7, v7
  v_lshrrev_b32 v8, 1, v5
  v_lshl_add_u32 v7, v8, 6, v7
  v_and_b32 v8, 3, v4
  v_lshl_add_u32 v7, v8, 4, v7
  s_mul_i32 s75, s62, 4224
  s_add_u32 s75, s75, 11534336
  s_setprio 3
  s_mov_b64 exec, 7
  s_waitcnt vmcnt(0)
  v_and_b32 v14, 0xff, v14
  v_cmp_gt_u32 vcc, 32, v14
  s_mov_b64 exec, -1
  s_cbranch_vccnz SL_54
BK_55:
SP_58:
  ds_read_b32 v3, v1 offset:1044
  s_waitcnt lgkmcnt(0)
  v_cmp_ne_u32 vcc, 0, v3
  s_cbranch_vccz SO_59
  s_sleep 2
  s_sub_u32 s12, s12, 1
  s_cbranch_scc0 SP_58
  s_mov_b32 s12, 0
SO_59:
  v_lshlrev_b32 v2, 4, v0
  s_mul_i32 s63, s62, 4224
  s_add_u32 s63, s63, 8388608
  s_mul_i32 s64, s60, 4608
  s_add_u32 m0, s64, 2048
  s_nop 0
  buffer_load_dwordx4 v2, s[48:51], s63 offen offset:0 sc1 lds
  buffer_load_dwordx4 v2, s[48:51], s63 offen offset:1024 sc1 lds
  buffer_load_dwordx4 v2, s[48:51], s63 offen offset:2048 sc1 lds
  buffer_load_dwordx4 v2, s[48:51], s63 offen offset:3072 sc1 lds
  s_setprio 0
SP_60:
  ds_read_b32 v3, v1 offset:1044
  s_waitcnt lgkmcnt(0)
  v_cmp_ne_u32 vcc, 0, v3
  s_cbranch_vccz SO_61
  s_sleep 2
  s_sub_u32 s12, s12, 1
  s_cbranch_scc0 SP_60
  s_mov_b32 s12, 0
SO_61:
SP_62:
  ds_read_b32 v3, v13 offset:1200
  s_waitcnt lgkmcnt(0)
  v_cmp_ne_u32 vcc, 0, v3
  s_cbranch_vccz SO_63
  s_sleep 2
  s_sub_u32 s12, s12, 1
  s_cbranch_scc0 SP_62
  s_mov_b32 s12, 0
SO_63:
  s_setprio 1
  ds_write_b64 v193, v[172:173] offset:1072
  ds_write_b64 v193, v[174:175] offset:5112
  ds_write_b64 v193, v[176:177] offset:3768
  ds_write_b64 v193, v[178:179] offset:2424
  ds_write_b64 v193, v[180:181] offset:560
  ds_write_b64 v193, v[182:183] offset:4600
  ds_write_b64 v193, v[184:185] offset:3256
  ds_write_b64 v193, v[186:187] offset:1912
  ds_write_b16 v194, v188 offset:5504
  ds_write_b16_d16_hi v194, v188 offset:5632
  ds_write_b16 v195, v189 offset:6016
  ds_write_b16_d16_hi v195, v189 offset:6144
  s_mov_b64 exec, 63
  ds_write_b64 v192, v[190:191]
  s_mov_b64 exec, -1
  s_mov_b64 exec, 1
  ds_write_b32 v196, v1 offset:1280
  s_mov_b64 exec, -1
  s_setprio 1
  v_mov_b32 v9, v13
  ds_read_b64 v[32:33], v197 offset:1096
  ds_read_b64 v[34:35], v197 offset:1104
  ds_read_b64 v[36:37], v197 offset:1032
  ds_read_b64 v[38:39], v197 offset:1040
  ds_read_b64 v[40:41], v197 offset:968
  ds_read_b64 v[42:43], v197 offset:976
  ds_read_b64 v[44:45], v197 offset:904
  ds_read_b64 v[46:47], v197 offset:912
  ds_read_b64 v[48:49], v197 offset:840
  ds_read_b64 v[50:51], v197 offset:848
  ds_read_b64 v[52:53], v197 offset:776
  ds_read_b64 v[54:55], v197 offset:784
  ds_read_b64 v[56:57], v197 offset:712
  ds_read_b64 v[58:59], v197 offset:720
  ds_read_b64 v[60:61], v197 offset:648
  ds_read_b64 v[62:63], v197 offset:656
  ds_read_b64 v[64:65], v197 offset:584
  ds_read_b64 v[66:67], v197 offset:592
  ds_read_b64 v[68:69], v197 offset:520
  ds_read_b64 v[70:71], v197 offset:528
  ds_read_b64 v[72:73], v197 offset:456
  ds_read_b64 v[74:75], v197 offset:464
  ds_read_b64 v[76:77], v197 offset:392
  ds_read_b64 v[78:79], v197 offset:400
  ds_read_b64 v[80:81], v197 offset:328
  ds_read_b64 v[82:83], v197 offset:336
  ds_read_b64 v[84:85], v197 offset:264
  ds_read_b64 v[86:87], v197 offset:272
  ds_read_b64 v[88:89], v197 offset:200
  ds_read_b64 v[90:91], v197 offset:208
  ds_read_b64 v[92:93], v197 offset:136
  ds_read_b64 v[94:95], v197 offset:144
  ds_read_b64 v[96:97], v197 offset:72
  ds_read_b64 v[98:99], v197 offset:80
  ds_read_b64 v[100:101], v198 offset:5504
  ds_read_b64 v[102:103], v198 offset:5496
  ds_read_b64 v[104:105], v198 offset:5488
  ds_read_b64 v[106:107], v198 offset:5480
  ds_read_b64 v[108:109], v198 offset:5632
  ds_read_b64 v[110:111], v198 offset:5624
  ds_read_b64 v[112:113], v198 offset:5616
  ds_read_b64 v[114:115], v198 offset:5608
  ds_read_b64 v[116:117], v198 offset:5760
  ds_read_b64 v[118:119], v198 offset:5752
  ds_read_b64 v[120:121], v198 offset:5744
  ds_read_b64 v[122:123], v198 offset:5736
  ds_read_b32 v124, v199 offset:5952
  ds_read_b32 v125, v199 offset:5948
  ds_read_b32 v126, v199 offset:5944
  ds_read_b32 v127, v199 offset:5940
  ds_read_b32 v128, v199 offset:6016
  ds_read_b32 v129, v199 offset:6012
  ds_read_b32 v130, v199 offset:6008
  ds_read_b32 v131, v199 offset:6004
  ds_read_b32 v132, v199 offset:6080
  ds_read_b32 v133, v199 offset:6076
  ds_read_b32 v134, v199 offset:6072
  ds_read_b32 v135, v199 offset:6068
  ds_read_b32 v136, v199 offset:6144
  ds_read_b32 v137, v199 offset:6140
  ds_read_b32 v138, v199 offset:6136
  ds_read_b32 v139, v199 offset:6132
  v_mov_b32 v12, s69
  v_mov_b32 v13, s69
  v_mov_b32 v14, s69
  v_mov_b32 v15, s69
  s_waitcnt vmcnt(0)
  s_setprio 1
  ds_read_b128 v[172:175], v6 offset:464
  ds_read_b128 v[176:179], v6 offset:448
  ds_read_b128 v[180:183], v6 offset:400
  ds_read_b128 v[184:187], v6 offset:336
  ds_read_b128 v[188:191], v6 offset:272
  ds_read_b128 v[192:195], v6 offset:208
  s_waitcnt lgkmcnt(5)
  v_mfma_f32_16x16x32_bf16 v[204:207], v[172:175], v[228:231], 0
  ds_read_b128 v[196:199], v6 offset:144
  v_mfma_f32_16x16x32_bf16 v[208:211], v[172:175], v[232:235], 0
  v_mfma_f32_16x16x32_bf16 v[212:215], v[172:175], v[236:239], 0
  v_mfma_f32_16x16x32_bf16 v[16:19], v[172:175], v[240:243], 0
  v_mfma_f32_16x16x32_bf16 v[140:143], v[32:35], v[172:175], v[12:15]
  v_mfma_f32_16x16x32_bf16 v[144:147], v[64:67], v[172:175], v[12:15]
  v_mfma_f32_16x16x32_bf16 v[148:151], v[96:99], v[172:175], v[12:15]
  v_mfma_f32_16x16x32_bf16 v[156:159], v[252:255], v[172:175], v[12:15]
  s_waitcnt lgkmcnt(5)
  v_mfma_f32_16x16x32_bf16 v[216:219], v[176:179], v[232:235], 0
  ds_read_b128 v[200:203], v6 offset:80
  v_mfma_f32_16x16x32_bf16 v[20:23], v[176:179], v[244:247], 0
  s_waitcnt lgkmcnt(5)
  v_mfma_f32_16x16x32_bf16 v[144:147], v[68:71], v[180:183], v[144:147]
  ds_read_b128 v[172:175], v6 offset:16
  v_cvt_pk_bf16_f32 v220, v204, v208
  v_mfma_f32_16x16x32_bf16 v[140:143], v[36:39], v[180:183], v[140:143]
  v_cvt_pk_bf16_f32 v222, v205, v209
  s_waitcnt lgkmcnt(5)
  v_mfma_f32_16x16x32_bf16 v[140:143], v[40:43], v[184:187], v[140:143]
  ds_read_b128 v[176:179], v6 offset:976
  v_cvt_pk_bf16_f32 v221, v212, v216
  v_mfma_f32_16x16x32_bf16 v[144:147], v[72:75], v[184:187], v[144:147]
  v_cvt_pk_bf16_f32 v223, v213, v217
  s_waitcnt lgkmcnt(5)
  v_mfma_f32_16x16x32_bf16 v[144:147], v[76:79], v[188:191], v[144:147]
  ds_read_b128 v[180:183], v6 offset:960
  v_mfma_f32_16x16x32_bf16 v[140:143], v[44:47], v[188:191], v[140:143]
  v_cvt_pk_bf16_f32 v224, v206, v210
  v_mfma_f32_16x16x32_bf16 v[148:151], v[220:223], v[100:103], v[148:151]
  v_cvt_pk_bf16_f32 v226, v207, v211
  v_mfma_f32_16x16x32_bf16 v[152:155], v[220:223], v[108:111], v[12:15]
  v_cvt_pk_bf16_f32 v225, v214, v218
  v_mfma_f32_16x16x32_bf16 v[156:159], v[220:223], v[116:119], v[156:159]
  v_cvt_pk_bf16_f32 v227, v215, v219
  s_waitcnt lgkmcnt(5)
  v_mfma_f32_16x16x32_bf16 v[140:143], v[48:51], v[192:195], v[140:143]
  ds_read_b128 v[184:187], v6 offset:912
  v_mfma_f32_16x16x32_bf16 v[144:147], v[80:83], v[192:195], v[144:147]
  v_cvt_pk_bf16_f32 v24, v16, v20
  v_mfma_f32_16x16x32_bf16 v[148:151], v[224:227], v[104:107], v[148:151]
  v_cvt_pk_bf16_f32 v25, v17, v21
  v_mfma_f32_16x16x32_bf16 v[152:155], v[224:227], v[112:115], v[152:155]
  v_cvt_pk_bf16_f32 v26, v18, v22
  v_mfma_f32_16x16x32_bf16 v[156:159], v[224:227], v[120:123], v[156:159]
  v_cvt_pk_bf16_f32 v27, v19, v23
  s_waitcnt lgkmcnt(5)
  v_mfma_f32_16x16x32_bf16 v[144:147], v[84:87], v[196:199], v[144:147]
  ds_read_b128 v[188:191], v6 offset:848
  v_mfma_f32_16x16x32_bf16 v[140:143], v[52:55], v[196:199], v[140:143]
  v_mfma_f32_16x16x32_bf16 v[156:159], v[24:27], v[124:127], v[156:159]
  v_mfma_f32_16x16x32_bf16 v[160:163], v[24:27], v[128:131], v[12:15]
  v_mfma_f32_16x16x32_bf16 v[164:167], v[24:27], v[132:135], v[12:15]
  v_mfma_f32_16x16x32_bf16 v[168:171], v[24:27], v[136:139], v[12:15]
  s_waitcnt lgkmcnt(5)
  v_mfma_f32_16x16x32_bf16 v[140:143], v[56:59], v[200:203], v[140:143]
  ds_read_b128 v[192:195], v6 offset:784
  v_mfma_f32_16x16x32_bf16 v[144:147], v[88:91], v[200:203], v[144:147]
  s_waitcnt lgkmcnt(5)
  v_mfma_f32_16x16x32_bf16 v[144:147], v[92:95], v[172:175], v[144:147]
  ds_read_b128 v[196:199], v6 offset:720
  v_mov_b32 v8, s47
  v_mfma_f32_16x16x32_bf16 v[140:143], v[60:63], v[172:175], v[140:143]
  s_mov_b64 exec, 1
  ds_write_b32 v8, v1 offset:1296
  s_mov_b64 exec, -1
  s_waitcnt lgkmcnt(6)
  v_mfma_f32_16x16x32_bf16 v[204:207], v[176:179], v[228:231], 0
  ds_read_b128 v[200:203], v6 offset:656
  v_mfma_f32_16x16x32_bf16 v[208:211], v[176:179], v[232:235], 0
  v_mfma_f32_16x16x32_bf16 v[212:215], v[176:179], v[236:239], 0
  v_mfma_f32_16x16x32_bf16 v[16:19], v[176:179], v[240:243], 0
  v_mfma_f32_16x16x32_bf16 v[144:147], v[32:35], v[176:179], v[144:147]
  v_mfma_f32_16x16x32_bf16 v[148:151], v[64:67], v[176:179], v[148:151]
  v_mfma_f32_16x16x32_bf16 v[152:155], v[96:99], v[176:179], v[152:155]
  v_mfma_f32_16x16x32_bf16 v[160:163], v[252:255], v[176:179], v[160:163]
  s_waitcnt lgkmcnt(6)
  v_mfma_f32_16x16x32_bf16 v[216:219], v[180:183], v[232:235], 0
  ds_read_b128 v[172:175], v6 offset:592
  v_mfma_f32_16x16x32_bf16 v[20:23], v[180:183], v[244:247], 0
  s_waitcnt lgkmcnt(6)
  v_mfma_f32_16x16x32_bf16 v[148:151], v[68:71], v[184:187], v[148:151]
  ds_read_b128 v[176:179], v6 offset:528
  v_cvt_pk_bf16_f32 v220, v204, v208
  v_mfma_f32_16x16x32_bf16 v[144:147], v[36:39], v[184:187], v[144:147]
  v_cvt_pk_bf16_f32 v222, v205, v209
  s_waitcnt lgkmcnt(6)
  v_mfma_f32_16x16x32_bf16 v[144:147], v[40:43], v[188:191], v[144:147]
  ds_read_b128 v[180:183], v6 offset:1488
  v_cvt_pk_bf16_f32 v221, v212, v216
  v_mfma_f32_16x16x32_bf16 v[148:151], v[72:75], v[188:191], v[148:151]
  v_cvt_pk_bf16_f32 v223, v213, v217
  s_waitcnt lgkmcnt(6)
  v_mfma_f32_16x16x32_bf16 v[148:151], v[76:79], v[192:195], v[148:151]
  ds_read_b128 v[184:187], v6 offset:1472
  v_mfma_f32_16x16x32_bf16 v[144:147], v[44:47], v[192:195], v[144:147]
  v_cvt_pk_bf16_f32 v224, v206, v210
  v_mfma_f32_16x16x32_bf16 v[152:155], v[220:223], v[100:103], v[152:155]
  v_cvt_pk_bf16_f32 v226, v207, v211
  v_mfma_f32_16x16x32_bf16 v[156:159], v[220:223], v[108:111], v[156:159]
  v_cvt_pk_bf16_f32 v225, v214, v218
  v_mfma_f32_16x16x32_bf16 v[160:163], v[220:223], v[116:119], v[160:163]
  v_cvt_pk_bf16_f32 v227, v215, v219
  s_waitcnt lgkmcnt(6)
  v_mfma_f32_16x16x32_bf16 v[144:147], v[48:51], v[196:199], v[144:147]
  ds_read_b128 v[188:191], v6 offset:1424
  v_mfma_f32_16x16x32_bf16 v[148:151], v[80:83], v[196:199], v[148:151]
  v_cvt_pk_bf16_f32 v24, v16, v20
  v_mfma_f32_16x16x32_bf16 v[152:155], v[224:227], v[104:107], v[152:155]
  v_cvt_pk_bf16_f32 v25, v17, v21
  v_mfma_f32_16x16x32_bf16 v[156:159], v[224:227], v[112:115], v[156:159]
  v_cvt_pk_bf16_f32 v26, v18, v22
  v_mfma_f32_16x16x32_bf16 v[160:163], v[224:227], v[120:123], v[160:163]
  v_cvt_pk_bf16_f32 v27, v19, v23
  s_waitcnt lgkmcnt(5)
  v_mfma_f32_16x16x32_bf16 v[148:151], v[84:87], v[200:203], v[148:151]
  ds_read_b128 v[192:195], v6 offset:1360
  v_mfma_f32_16x16x32_bf16 v[144:147], v[52:55], v[200:203], v[144:147]
  v_mfma_f32_16x16x32_bf16 v[160:163], v[24:27], v[124:127], v[160:163]
  v_mfma_f32_16x16x32_bf16 v[164:167], v[24:27], v[128:131], v[164:167]
  v_mfma_f32_16x16x32_bf16 v[168:171], v[24:27], v[132:135], v[168:171]
  s_waitcnt lgkmcnt(5)
  v_mfma_f32_16x16x32_bf16 v[144:147], v[56:59], v[172:175], v[144:147]
  ds_read_b128 v[196:199], v6 offset:1296
  v_mfma_f32_16x16x32_bf16 v[148:151], v[88:91], v[172:175], v[148:151]
  s_waitcnt lgkmcnt(5)
  v_mfma_f32_16x16x32_bf16 v[148:151], v[92:95], v[176:179], v[148:151]
  ds_read_b128 v[200:203], v6 offset:1232
  v_mfma_f32_16x16x32_bf16 v[144:147], v[60:63], v[176:179], v[144:147]
  s_waitcnt lgkmcnt(5)
  v_mfma_f32_16x16x32_bf16 v[204:207], v[180:183], v[228:231], 0
  ds_read_b128 v[172:175], v6 offset:1168
  v_mfma_f32_16x16x32_bf16 v[208:211], v[180:183], v[232:235], 0
  v_mfma_f32_16x16x32_bf16 v[212:215], v[180:183], v[236:239], 0
  v_mfma_f32_16x16x32_bf16 v[16:19], v[180:183], v[240:243], 0
  v_mfma_f32_16x16x32_bf16 v[148:151], v[32:35], v[180:183], v[148:151]
  v_mfma_f32_16x16x32_bf16 v[152:155], v[64:67], v[180:183], v[152:155]
  v_mfma_f32_16x16x32_bf16 v[156:159], v[96:99], v[180:183], v[156:159]
  v_mfma_f32_16x16x32_bf16 v[164:167], v[252:255], v[180:183], v[164:167]
  s_waitcnt lgkmcnt(5)
  v_mfma_f32_16x16x32_bf16 v[216:219], v[184:187], v[232:235], 0
  ds_read_b128 v[176:179], v6 offset:1104
  v_mfma_f32_16x16x32_bf16 v[20:23], v[184:187], v[244:247], 0
  s_waitcnt lgkmcnt(5)
  v_mfma_f32_16x16x32_bf16 v[152:155], v[68:71], v[188:191], v[152:155]
  ds_read_b128 v[180:183], v6 offset:1040
  v_cvt_pk_bf16_f32 v220, v204, v208
  v_mfma_f32_16x16x32_bf16 v[148:151], v[36:39], v[188:191], v[148:151]
  v_cvt_pk_bf16_f32 v222, v205, v209
  s_waitcnt lgkmcnt(5)
  v_mfma_f32_16x16x32_bf16 v[148:151], v[40:43], v[192:195], v[148:151]
  ds_read_b128 v[184:187], v6 offset:2000
  v_cvt_pk_bf16_f32 v221, v212, v216
  v_mfma_f32_16x16x32_bf16 v[152:155], v[72:75], v[192:195], v[152:155]
  v_cvt_pk_bf16_f32 v223, v213, v217
  s_waitcnt lgkmcnt(5)
  v_mfma_f32_16x16x32_bf16 v[152:155], v[76:79], v[196:199], v[152:155]
  ds_read_b128 v[188:191], v6 offset:1984
  v_mfma_f32_16x16x32_bf16 v[148:151], v[44:47], v[196:199], v[148:151]
  v_cvt_pk_bf16_f32 v224, v206, v210
  v_mfma_f32_16x16x32_bf16 v[156:159], v[220:223], v[100:103], v[156:159]
  v_cvt_pk_bf16_f32 v226, v207, v211
  v_mfma_f32_16x16x32_bf16 v[160:163], v[220:223], v[108:111], v[160:163]
  v_cvt_pk_bf16_f32 v225, v214, v218
  v_mfma_f32_16x16x32_bf16 v[164:167], v[220:223], v[116:119], v[164:167]
  v_cvt_pk_bf16_f32 v227, v215, v219
  s_waitcnt lgkmcnt(5)
  v_mfma_f32_16x16x32_bf16 v[148:151], v[48:51], v[200:203], v[148:151]
  ds_read_b128 v[192:195], v6 offset:1936
  v_mfma_f32_16x16x32_bf16 v[152:155], v[80:83], v[200:203], v[152:155]
  v_cvt_pk_bf16_f32 v24, v16, v20
  v_mfma_f32_16x16x32_bf16 v[156:159], v[224:227], v[104:107], v[156:159]
  v_cvt_pk_bf16_f32 v25, v17, v21
  v_mfma_f32_16x16x32_bf16 v[160:163], v[224:227], v[112:115], v[160:163]
  v_cvt_pk_bf16_f32 v26, v18, v22
  v_mfma_f32_16x16x32_bf16 v[164:167], v[224:227], v[120:123], v[164:167]
  v_cvt_pk_bf16_f32 v27, v19, v23
  s_waitcnt lgkmcnt(5)
  v_mfma_f32_16x16x32_bf16 v[152:155], v[84:87], v[172:175], v[152:155]
  ds_read_b128 v[196:199], v6 offset:1872
  v_mfma_f32_16x16x32_bf16 v[148:151], v[52:55], v[172:175], v[148:151]
  v_cvt_pk_bf16_f32 v28, v140, v141
  v_mfma_f32_16x16x32_bf16 v[164:167], v[24:27], v[124:127], v[164:167]
  v_cvt_pk_bf16_f32 v30, v144, v145
  v_mfma_f32_16x16x32_bf16 v[168:171], v[24:27], v[128:131], v[168:171]
  v_cvt_pk_bf16_f32 v29, v142, v143
  s_waitcnt lgkmcnt(5)
  v_mfma_f32_16x16x32_bf16 v[148:151], v[56:59], v[176:179], v[148:151]
  ds_read_b128 v[200:203], v6 offset:1808
  v_cvt_pk_bf16_f32 v31, v146, v147
  v_mfma_f32_16x16x32_bf16 v[152:155], v[88:91], v[176:179], v[152:155]
  v_permlane16_swap_b32 v28, v30
  s_waitcnt lgkmcnt(5)
  v_mfma_f32_16x16x32_bf16 v[152:155], v[92:95], v[180:183], v[152:155]
  ds_read_b128 v[172:175], v6 offset:1744
  v_permlane16_swap_b32 v29, v31
  v_mfma_f32_16x16x32_bf16 v[148:151], v[60:63], v[180:183], v[148:151]
  s_setprio 3
  buffer_store_dwordx4 v[28:31], v7, s[48:51], s75 offen offset:0 sc1
  s_setprio 1
  s_waitcnt lgkmcnt(5)
  v_mfma_f32_16x16x32_bf16 v[204:207], v[184:187], v[228:231], 0
  ds_read_b128 v[176:179], v6 offset:1680
  v_mfma_f32_16x16x32_bf16 v[208:211], v[184:187], v[232:235], 0
  v_mfma_f32_16x16x32_bf16 v[212:215], v[184:187], v[236:239], 0
  v_mfma_f32_16x16x32_bf16 v[16:19], v[184:187], v[240:243], 0
  v_mfma_f32_16x16x32_bf16 v[152:155], v[32:35], v[184:187], v[152:155]
  v_mfma_f32_16x16x32_bf16 v[156:159], v[64:67], v[184:187], v[156:159]
  v_mfma_f32_16x16x32_bf16 v[160:163], v[96:99], v[184:187], v[160:163]
  v_mfma_f32_16x16x32_bf16 v[168:171], v[252:255], v[184:187], v[168:171]
  s_waitcnt lgkmcnt(5)
  v_mfma_f32_16x16x32_bf16 v[216:219], v[188:191], v[232:235], 0
  ds_read_b128 v[180:183], v6 offset:1616
  v_mfma_f32_16x16x32_bf16 v[20:23], v[188:191], v[244:247], 0
  s_waitcnt lgkmcnt(5)
  v_mfma_f32_16x16x32_bf16 v[156:159], v[68:71], v[192:195], v[156:159]
  ds_read_b128 v[184:187], v6 offset:1552
  v_cvt_pk_bf16_f32 v220, v204, v208
  v_mfma_f32_16x16x32_bf16 v[152:155], v[36:39], v[192:195], v[152:155]
  v_cvt_pk_bf16_f32 v222, v205, v209
  s_waitcnt lgkmcnt(5)
  v_mfma_f32_16x16x32_bf16 v[152:155], v[40:43], v[196:199], v[152:155]
  ds_read_b128 v[188:191], v6 offset:2512
  v_cvt_pk_bf16_f32 v221, v212, v216
  v_mfma_f32_16x16x32_bf16 v[156:159], v[72:75], v[196:199], v[156:159]
  v_cvt_pk_bf16_f32 v223, v213, v217
  s_waitcnt lgkmcnt(5)
  v_mfma_f32_16x16x32_bf16 v[156:159], v[76:79], v[200:203], v[156:159]
  ds_read_b128 v[192:195], v6 offset:2496
  v_mfma_f32_16x16x32_bf16 v[152:155], v[44:47], v[200:203], v[152:155]
  v_cvt_pk_bf16_f32 v224, v206, v210
  v_mfma_f32_16x16x32_bf16 v[160:163], v[220:223], v[100:103], v[160:163]
  v_cvt_pk_bf16_f32 v226, v207, v211
  v_mfma_f32_16x16x32_bf16 v[164:167], v[220:223], v[108:111], v[164:167]
  v_cvt_pk_bf16_f32 v225, v214, v218
  v_mfma_f32_16x16x32_bf16 v[168:171], v[220:223], v[116:119], v[168:171]
  v_cvt_pk_bf16_f32 v227, v215, v219
  s_waitcnt lgkmcnt(5)
  v_mfma_f32_16x16x32_bf16 v[152:155], v[48:51], v[172:175], v[152:155]
  ds_read_b128 v[196:199], v6 offset:2448
  v_mfma_f32_16x16x32_bf16 v[156:159], v[80:83], v[172:175], v[156:159]
  v_cvt_pk_bf16_f32 v24, v16, v20
  v_mfma_f32_16x16x32_bf16 v[160:163], v[224:227], v[104:107], v[160:163]
  v_cvt_pk_bf16_f32 v25, v17, v21
  v_mfma_f32_16x16x32_bf16 v[164:167], v[224:227], v[112:115], v[164:167]
  v_cvt_pk_bf16_f32 v26, v18, v22
  v_mfma_f32_16x16x32_bf16 v[168:171], v[224:227], v[120:123], v[168:171]
  v_cvt_pk_bf16_f32 v27, v19, v23
  s_waitcnt lgkmcnt(5)
  v_mfma_f32_16x16x32_bf16 v[156:159], v[84:87], v[176:179], v[156:159]
  ds_read_b128 v[200:203], v6 offset:2384
  v_mfma_f32_16x16x32_bf16 v[152:155], v[52:55], v[176:179], v[152:155]
  v_mfma_f32_16x16x32_bf16 v[168:171], v[24:27], v[124:127], v[168:171]
  s_waitcnt lgkmcnt(5)
  v_mfma_f32_16x16x32_bf16 v[152:155], v[56:59], v[180:183], v[152:155]
  ds_read_b128 v[172:175], v6 offset:2320
  v_mfma_f32_16x16x32_bf16 v[156:159], v[88:91], v[180:183], v[156:159]
  s_waitcnt lgkmcnt(5)
  v_mfma_f32_16x16x32_bf16 v[156:159], v[92:95], v[184:187], v[156:159]
  ds_read_b128 v[176:179], v6 offset:2256
  v_mfma_f32_16x16x32_bf16 v[152:155], v[60:63], v[184:187], v[152:155]
  s_waitcnt lgkmcnt(5)
  v_mfma_f32_16x16x32_bf16 v[204:207], v[188:191], v[228:231], 0
  ds_read_b128 v[180:183], v6 offset:2192
  v_mfma_f32_16x16x32_bf16 v[208:211], v[188:191], v[232:235], 0
  v_mfma_f32_16x16x32_bf16 v[212:215], v[188:191], v[236:239], 0
  v_mfma_f32_16x16x32_bf16 v[156:159], v[32:35], v[188:191], v[156:159]
  v_mfma_f32_16x16x32_bf16 v[160:163], v[64:67], v[188:191], v[160:163]
  v_mfma_f32_16x16x32_bf16 v[164:167], v[96:99], v[188:191], v[164:167]
  s_waitcnt lgkmcnt(5)
  v_mfma_f32_16x16x32_bf16 v[216:219], v[192:195], v[232:235], 0
  ds_read_b128 v[184:187], v6 offset:2128
  s_waitcnt lgkmcnt(5)
  v_mfma_f32_16x16x32_bf16 v[160:163], v[68:71], v[196:199], v[160:163]
  ds_read_b128 v[188:191], v6 offset:2064
  v_cvt_pk_bf16_f32 v220, v204, v208
  v_mfma_f32_16x16x32_bf16 v[156:159], v[36:39], v[196:199], v[156:159]
  v_cvt_pk_bf16_f32 v222, v205, v209
  s_waitcnt lgkmcnt(5)
  v_mfma_f32_16x16x32_bf16 v[156:159], v[40:43], v[200:203], v[156:159]
  ds_read_b128 v[192:195], v6 offset:3024
  v_cvt_pk_bf16_f32 v221, v212, v216
  v_mfma_f32_16x16x32_bf16 v[160:163], v[72:75], v[200:203], v[160:163]
  v_cvt_pk_bf16_f32 v223, v213, v217
  s_waitcnt lgkmcnt(5)
  v_mfma_f32_16x16x32_bf16 v[160:163], v[76:79], v[172:175], v[160:163]
  ds_read_b128 v[196:199], v6 offset:3008
  v_cvt_pk_bf16_f32 v224, v206, v210
  v_mfma_f32_16x16x32_bf16 v[156:159], v[44:47], v[172:175], v[156:159]
  v_cvt_pk_bf16_f32 v226, v207, v211
  v_mfma_f32_16x16x32_bf16 v[164:167], v[220:223], v[100:103], v[164:167]
  v_cvt_pk_bf16_f32 v225, v214, v218
  v_mfma_f32_16x16x32_bf16 v[168:171], v[220:223], v[108:111], v[168:171]
  v_cvt_pk_bf16_f32 v227, v215, v219
  s_waitcnt lgkmcnt(5)
  v_mfma_f32_16x16x32_bf16 v[156:159], v[48:51], v[176:179], v[156:159]
  ds_read_b128 v[200:203], v6 offset:2960
  v_mfma_f32_16x16x32_bf16 v[160:163], v[80:83], v[176:179], v[160:163]
  v_mfma_f32_16x16x32_bf16 v[164:167], v[224:227], v[104:107], v[164:167]
  v_mfma_f32_16x16x32_bf16 v[168:171], v[224:227], v[112:115], v[168:171]
  s_waitcnt lgkmcnt(5)
  v_mfma_f32_16x16x32_bf16 v[160:163], v[84:87], v[180:183], v[160:163]
  ds_read_b128 v[172:175], v6 offset:2896
  v_cvt_pk_bf16_f32 v28, v148, v149
  v_mfma_f32_16x16x32_bf16 v[156:159], v[52:55], v[180:183], v[156:159]
  v_cvt_pk_bf16_f32 v30, v152, v153
  v_cvt_pk_bf16_f32 v29, v150, v151
  s_waitcnt lgkmcnt(5)
  v_mfma_f32_16x16x32_bf16 v[156:159], v[56:59], v[184:187], v[156:159]
  ds_read_b128 v[176:179], v6 offset:2832
  v_cvt_pk_bf16_f32 v31, v154, v155
  v_mfma_f32_16x16x32_bf16 v[160:163], v[88:91], v[184:187], v[160:163]
  v_permlane16_swap_b32 v28, v30
  s_waitcnt lgkmcnt(5)
  v_mfma_f32_16x16x32_bf16 v[160:163], v[92:95], v[188:191], v[160:163]
  ds_read_b128 v[180:183], v6 offset:2768
  v_permlane16_swap_b32 v29, v31
  v_mfma_f32_16x16x32_bf16 v[156:159], v[60:63], v[188:191], v[156:159]
  s_setprio 3
  buffer_store_dwordx4 v[28:31], v7, s[48:51], s75 offen offset:1024 sc1
  s_setprio 1
  s_waitcnt lgkmcnt(5)
  v_mfma_f32_16x16x32_bf16 v[204:207], v[192:195], v[228:231], 0
  ds_read_b128 v[184:187], v6 offset:2704
  v_mfma_f32_16x16x32_bf16 v[208:211], v[192:195], v[232:235], 0
  v_mfma_f32_16x16x32_bf16 v[212:215], v[192:195], v[236:239], 0
  v_mfma_f32_16x16x32_bf16 v[160:163], v[32:35], v[192:195], v[160:163]
  v_mfma_f32_16x16x32_bf16 v[164:167], v[64:67], v[192:195], v[164:167]
  v_mfma_f32_16x16x32_bf16 v[168:171], v[96:99], v[192:195], v[168:171]
  s_waitcnt lgkmcnt(5)
  v_mfma_f32_16x16x32_bf16 v[216:219], v[196:199], v[232:235], 0
  ds_read_b128 v[188:191], v6 offset:2640
  s_waitcnt lgkmcnt(5)
  v_mfma_f32_16x16x32_bf16 v[164:167], v[68:71], v[200:203], v[164:167]
  ds_read_b128 v[192:195], v6 offset:2576
  v_cvt_pk_bf16_f32 v220, v204, v208
  v_mfma_f32_16x16x32_bf16 v[160:163], v[36:39], v[200:203], v[160:163]
  v_cvt_pk_bf16_f32 v222, v205, v209
  s_waitcnt lgkmcnt(5)
  v_mfma_f32_16x16x32_bf16 v[160:163], v[40:43], v[172:175], v[160:163]
  ds_read_b128 v[196:199], v6 offset:3536
  v_cvt_pk_bf16_f32 v221, v212, v216
  v_mfma_f32_16x16x32_bf16 v[164:167], v[72:75], v[172:175], v[164:167]
  v_cvt_pk_bf16_f32 v223, v213, v217
  s_waitcnt lgkmcnt(5)
  v_mfma_f32_16x16x32_bf16 v[164:167], v[76:79], v[176:179], v[164:167]
  ds_read_b128 v[200:203], v6 offset:3472
  v_cvt_pk_bf16_f32 v224, v206, v210
  v_mfma_f32_16x16x32_bf16 v[160:163], v[44:47], v[176:179], v[160:163]
  v_cvt_pk_bf16_f32 v226, v207, v211
  v_cvt_pk_bf16_f32 v225, v214, v218
  v_mfma_f32_16x16x32_bf16 v[168:171], v[220:223], v[100:103], v[168:171]
  v_cvt_pk_bf16_f32 v227, v215, v219
  s_waitcnt lgkmcnt(5)
  v_mfma_f32_16x16x32_bf16 v[160:163], v[48:51], v[180:183], v[160:163]
  ds_read_b128 v[172:175], v6 offset:3408
  v_mfma_f32_16x16x32_bf16 v[164:167], v[80:83], v[180:183], v[164:167]
  v_mfma_f32_16x16x32_bf16 v[168:171], v[224:227], v[104:107], v[168:171]
  s_waitcnt lgkmcnt(5)
  v_mfma_f32_16x16x32_bf16 v[164:167], v[84:87], v[184:187], v[164:167]
  ds_read_b128 v[176:179], v6 offset:3344
  v_mfma_f32_16x16x32_bf16 v[160:163], v[52:55], v[184:187], v[160:163]
  s_waitcnt lgkmcnt(5)
  v_mfma_f32_16x16x32_bf16 v[160:163], v[56:59], v[188:191], v[160:163]
  ds_read_b128 v[180:183], v6 offset:3280
  v_mfma_f32_16x16x32_bf16 v[164:167], v[88:91], v[188:191], v[164:167]
  s_waitcnt lgkmcnt(5)
  v_mfma_f32_16x16x32_bf16 v[164:167], v[92:95], v[192:195], v[164:167]
  ds_read_b128 v[184:187], v6 offset:3216
  v_mfma_f32_16x16x32_bf16 v[160:163], v[60:63], v[192:195], v[160:163]
  s_waitcnt lgkmcnt(5)
  v_mfma_f32_16x16x32_bf16 v[164:167], v[32:35], v[196:199], v[164:167]
  ds_read_b128 v[188:191], v6 offset:3152
  v_mfma_f32_16x16x32_bf16 v[168:171], v[64:67], v[196:199], v[168:171]
  s_waitcnt lgkmcnt(5)
  v_mfma_f32_16x16x32_bf16 v[168:171], v[68:71], v[200:203], v[168:171]
  ds_read_b128 v[192:195], v6 offset:3088
  v_mfma_f32_16x16x32_bf16 v[164:167], v[36:39], v[200:203], v[164:167]
  s_waitcnt lgkmcnt(5)
  v_mfma_f32_16x16x32_bf16 v[164:167], v[40:43], v[172:175], v[164:167]
  ds_read_b128 v[196:199], v6 offset:4048
  v_mfma_f32_16x16x32_bf16 v[168:171], v[72:75], v[172:175], v[168:171]
  s_waitcnt lgkmcnt(5)
  v_mfma_f32_16x16x32_bf16 v[168:171], v[76:79], v[176:179], v[168:171]
  ds_read_b128 v[200:203], v6 offset:3984
  v_mfma_f32_16x16x32_bf16 v[164:167], v[44:47], v[176:179], v[164:167]
  s_waitcnt lgkmcnt(5)
  v_mfma_f32_16x16x32_bf16 v[164:167], v[48:51], v[180:183], v[164:167]
  ds_read_b128 v[172:175], v6 offset:3920
  v_mfma_f32_16x16x32_bf16 v[168:171], v[80:83], v[180:183], v[168:171]
  s_waitcnt lgkmcnt(5)
  v_mfma_f32_16x16x32_bf16 v[168:171], v[84:87], v[184:187], v[168:171]
  ds_read_b128 v[176:179], v6 offset:3856
  v_cvt_pk_bf16_f32 v28, v156, v157
  v_mfma_f32_16x16x32_bf16 v[164:167], v[52:55], v[184:187], v[164:167]
  v_cvt_pk_bf16_f32 v30, v160, v161
  v_cvt_pk_bf16_f32 v29, v158, v159
  s_waitcnt lgkmcnt(5)
  v_mfma_f32_16x16x32_bf16 v[164:167], v[56:59], v[188:191], v[164:167]
  ds_read_b128 v[180:183], v6 offset:3792
  v_cvt_pk_bf16_f32 v31, v162, v163
  v_mfma_f32_16x16x32_bf16 v[168:171], v[88:91], v[188:191], v[168:171]
  v_permlane16_swap_b32 v28, v30
  s_waitcnt lgkmcnt(5)
  v_mfma_f32_16x16x32_bf16 v[168:171], v[92:95], v[192:195], v[168:171]
  ds_read_b128 v[184:187], v6 offset:3728
  v_permlane16_swap_b32 v29, v31
  v_mfma_f32_16x16x32_bf16 v[164:167], v[60:63], v[192:195], v[164:167]
  s_setprio 3
  buffer_store_dwordx4 v[28:31], v7, s[48:51], s75 offen offset:2048 sc1
  s_setprio 1
  s_waitcnt lgkmcnt(5)
  v_mfma_f32_16x16x32_bf16 v[168:171], v[32:35], v[196:199], v[168:171]
  ds_read_b128 v[188:191], v6 offset:3664
  s_waitcnt lgkmcnt(5)
  v_mfma_f32_16x16x32_bf16 v[168:171], v[36:39], v[200:203], v[168:171]
  ds_read_b128 v[192:195], v6 offset:3600
  s_waitcnt lgkmcnt(5)
  v_mfma_f32_16x16x32_bf16 v[168:171], v[40:43], v[172:175], v[168:171]
  s_waitcnt lgkmcnt(4)
  v_mfma_f32_16x16x32_bf16 v[168:171], v[44:47], v[176:179], v[168:171]
  s_waitcnt lgkmcnt(3)
  v_mfma_f32_16x16x32_bf16 v[168:171], v[48:51], v[180:183], v[168:171]
  s_waitcnt lgkmcnt(2)
  v_mfma_f32_16x16x32_bf16 v[168:171], v[52:55], v[184:187], v[168:171]
  s_waitcnt lgkmcnt(1)
  v_mfma_f32_16x16x32_bf16 v[168:171], v[56:59], v[188:191], v[168:171]
  s_waitcnt lgkmcnt(0)
  v_mfma_f32_16x16x32_bf16 v[168:171], v[60:63], v[192:195], v[168:171]
  s_setprio 3
  v_cvt_pk_bf16_f32 v28, v164, v165
  s_nop 5
  v_cvt_pk_bf16_f32 v30, v168, v169
  v_cvt_pk_bf16_f32 v29, v166, v167
  v_cvt_pk_bf16_f32 v31, v170, v171
  v_permlane16_swap_b32 v28, v30
  s_nop 0
  v_permlane16_swap_b32 v29, v31
  s_setprio 3
  buffer_store_dwordx4 v[28:31], v7, s[48:51], s75 offen offset:3072 sc1
  s_setprio 3
  s_waitcnt vmcnt(0)
  v_mov_b32 v2, 256
  v_lshlrev_b32 v3, 7, v0
  s_mov_b64 exec, 255
  buffer_atomic_add v2, v3, s[48:51], s13 offen sc1
  s_mov_b64 exec, -1
  s_endpgm
SL_46:
  v_and_b32 v225, 7, v0
  v_lshlrev_b32 v225, 2, v225
SP_48:
  global_load_dword v224, v225, s[42:43] sc1
  s_waitcnt vmcnt(0)
  v_cmp_eq_u32 vcc, 0, v224
  s_cbranch_vccz SO_49
  s_sleep 1
  s_sub_u32 s12, s12, 1
  s_cbranch_scc0 SP_48
  s_mov_b32 s12, 0
SO_49:
  s_branch BK_47
SL_50:
SP_52:
  ds_read_b32 v3, v13 offset:1104
  s_waitcnt lgkmcnt(0)
  v_cmp_ne_u32 vcc, 0, v3
  s_cbranch_vccz SO_53
  s_sleep 2
  s_sub_u32 s12, s12, 1
  s_cbranch_scc0 SP_52
  s_mov_b32 s12, 0
SO_53:
  ds_read_b64 v[4:5], v12 offset:0
  ds_read_b64 v[6:7], v12 offset:512
  s_waitcnt lgkmcnt(0)
  s_branch BK_51
SL_54:
  v_lshlrev_b32 v15, 10, v0
  s_mov_b64 exec, 7
SP_56:
  v_mov_b32 v14, 0
  buffer_atomic_add v14, v15, s[48:51], s74 offen sc0 sc1
  s_waitcnt vmcnt(0)
  v_and_b32 v14, 0xff, v14
  v_cmp_gt_u32 vcc, 32, v14
  s_cbranch_vccz SO_57
  s_sleep 8
  s_sub_u32 s12, s12, 1
  s_cbranch_scc0 SP_56
  s_mov_b32 s12, 0
SO_57:
  s_mov_b64 exec, -1
  s_branch BK_55
.p2align 6
R_g:
  s_mul_i32 s63, s3, 448
  s_add_u32 s63, s63, 39168
  v_mul_u32_u24 v16, 43, v0
  v_lshrrev_b32 v16, 9, v16
  v_min_u32 v16, 4, v16
  v_mul_u32_u24 v17, 12, v16
  v_sub_u32 v17, v0, v17
  v_lshl_add_u32 v18, v16, 1, 3
  v_cmp_eq_u32 vcc, 4, v16
  v_mov_b32 v19, 0x3f80
  s_nop 0
  v_cndmask_b32_e64 v18, v18, 2, vcc
  v_cndmask_b32_e64 v19, v19, -1, vcc
  v_cmp_lt_u32 vcc, v17, v18
  v_min_u32 v18, 3, v16
  s_nop 0
  v_cndmask_b32 v19, 0, v19, vcc
  v_mul_u32_u24 v16, 40, v16
  v_sub_u32 v16, v16, v18
  v_add_u32 v16, v16, v17
  s_lshl_b32 s64, s3, 1
  s_add_u32 s63, s63, s64
  v_lshl_add_u32 v16, v16, 1, s63
  ds_write_b16 v16, v19 offset:54
  s_barrier
  s_mov_b32 s12, 0x400000
  s_mul_i32 s9, s4, 43
  s_lshr_b32 s9, s9, 7
  s_mul_i32 s10, s9, 3
  s_sub_u32 s6, s4, s10
  s_lshr_b32 s6, s4, 3
  s_cmp_eq_u32 s6, 3
  s_cselect_b32 s6, 2, s6
  s_lshr_b32 s60, s3, 1
  s_and_b32 s61, s3, 1
  s_lshl_b64 s[78:79], 1, s3
  v_mov_b32 v1, 0
  v_and_b32 v20, 31, v0
  v_lshrrev_b32 v21, 5, v0
  v_lshlrev_b32 v16, 1, v20
  s_mul_i32 s63, s5, 384
  s_lshl_b32 s64, s61, 6
  s_add_u32 s63, s63, s64
  s_add_u32 s52, s6, 0
  s_cmp_ge_u32 s52, 3
  s_cselect_b32 s64, 3, 0
  s_sub_u32 s52, s52, s64
  s_lshl_b32 s64, s52, 7
  s_add_u32 s64, s64, s63
  v_add_u32 v17, s64, v16
  v_mov_b32 v12, 0
  global_load_short_d16_hi v12, v17, s[34:35]
  s_add_u32 s53, s6, 1
  s_cmp_ge_u32 s53, 3
  s_cselect_b32 s64, 3, 0
  s_sub_u32 s53, s53, s64
  s_lshl_b32 s64, s53, 7
  s_add_u32 s64, s64, s63
  v_add_u32 v17, s64, v16
  v_mov_b32 v13, 0
  global_load_short_d16_hi v13, v17, s[34:35]
  s_add_u32 s54, s6, 2
  s_cmp_ge_u32 s54, 3
  s_cselect_b32 s64, 3, 0
  s_sub_u32 s54, s54, s64
  s_lshl_b32 s64, s54, 7
  s_add_u32 s64, s64, s63
  v_add_u32 v17, s64, v16
  v_mov_b32 v14, 0
  global_load_short_d16_hi v14, v17, s[34:35]
  s_lshl_b32 s63, s60, 12
  s_add_u32 s63, s63, 40960
  v_lshlrev_b32 v16, 7, v20
  v_add_u32 v16, s63, v16
  v_bfe_u32 v17, v20, 1, 3
  s_lshl_b32 s63, s61, 2
  v_xor_b32 v17, s63, v17
  v_xor_b32 v17, v17, v21
  v_lshl_add_u32 v24, v17, 4, v16
  v_xor_b32 v25, 32, v24
  v_xor_b32 v26, 64, v24
  v_xor_b32 v27, 96, v24
  v_bfe_u32 v16, v0, 2, 2
  v_lshl_add_u32 v17, v21, 3, v16
  v_lshlrev_b32 v17, 7, v17
  v_lshrrev_b32 v16, 1, v16
  v_xor_b32 v16, s61, v16
  v_lshl_add_u32 v17, v16, 6, v17
  v_bfe_u32 v16, v0, 4, 1
  v_lshl_add_u32 v17, v16, 5, v17
  v_and_b32 v16, 3, v0
  v_lshl_add_u32 v17, v16, 3, v17
  v_mov_b32 v8, 1024
  v_lshl_add_u32 v11, v16, 2, v8
  s_lshl_b32 s63, s61, 12
  s_add_u32 s64, s63, 122880
  v_add_u32 v2, s64, v17
  s_sub_u32 s64, 126976, s63
  v_add_u32 v3, s64, v17
  v_bfe_u32 v16, v0, 4, 1
  v_mul_u32_u24 v18, 49152, v16
  v_lshl_add_u32 v18, v21, 8, v18
  v_and_b32 v17, 15, v0
  v_lshl_add_u32 v4, v17, 4, v18
  v_bfe_u32 v16, v0, 1, 2
  v_mov_b32 v18, 0x3f803f80
  v_cmp_eq_u32 vcc, 0, v16
  s_nop 1
  v_cndmask_b32 v32, 0, v18, vcc
  v_cmp_eq_u32 vcc, 2, v16
  s_nop 1
  v_cndmask_b32 v34, 0, v18, vcc
  v_mov_b32 v33, v32
  v_mov_b32 v35, v34
  v_and_b32 v16, 1, v0
  v_mul_u32_u24 v16, 0xaaaa, v16
  v_or_b32 v5, 0x4444, v16
  s_lshl_b32 s63, s4, 1
  s_add_u32 s63, s63, s60
  s_lshl_b32 s77, s63, 8
  s_add_u32 s77, s77, 16777216
  s_mul_i32 s63, s63, 96
  s_lshl_b32 s64, s5, 1
  s_add_u32 s63, s63, s64
  s_add_u32 s63, s63, s61
  s_lshl_b32 s64, s52, 4
  s_add_u32 s64, s64, s63
  s_lshl_b32 s55, s64, 10
  s_lshl_b32 s64, s53, 4
  s_add_u32 s64, s64, s63
  s_lshl_b32 s56, s64, 10
  s_lshl_b32 s64, s54, 4
  s_add_u32 s64, s64, s63
  s_lshl_b32 s57, s64, 10
  s_lshl_b32 s63, s60, 8
  v_lshl_add_u32 v30, v20, 3, s63
  v_cmp_eq_u32 s[70:71], 0, v21
  v_lshlrev_b32 v15, 7, v0
  s_waitcnt vmcnt(3)
  s_cmp_lg_u32 s11, 0
  s_cbranch_scc1 NZ_64
  s_lshl_b32 s63, s2, 2
  v_mov_b32 v18, s63
  v_mov_b32 v19, 1
  s_mov_b64 exec, 1
  global_store_dword v18, v19, s[42:43] sc1
  s_mov_b64 exec, -1
NZ_64:
  v_mov_b32 v22, 0
  v_mov_b32 v23, 0
  v_mov_b32 v36, 0
  v_mov_b32 v37, 0
  v_mov_b32 v38, 0
  v_mov_b32 v39, 0
  s_setprio 2
SP_65:
  ds_read_b32 v9, v8 offset:0
  s_waitcnt lgkmcnt(0)
  v_cmp_ne_u32 vcc, 0, v9
  s_cbranch_vccz SO_66
  s_sleep 2
  s_sub_u32 s12, s12, 1
  s_cbranch_scc0 SP_65
  s_mov_b32 s12, 0
SO_66:
  ds_read_b128 v[96:99], v24 offset:0
  ds_read_b128 v[100:103], v25 offset:0
  ds_read_b128 v[112:115], v24 offset:8192
  ds_read_b128 v[116:119], v25 offset:8192
  ds_read_b128 v[128:131], v24 offset:16384
  ds_read_b128 v[132:135], v25 offset:16384
  ds_read_b128 v[144:147], v24 offset:24576
  ds_read_b128 v[148:151], v25 offset:24576
  ds_read_b128 v[160:163], v24 offset:32768
  ds_read_b128 v[164:167], v25 offset:32768
  ds_read_b128 v[104:107], v26 offset:0
  ds_read_b128 v[108:111], v27 offset:0
  ds_read_b128 v[120:123], v26 offset:8192
  ds_read_b128 v[124:127], v27 offset:8192
  ds_read_b128 v[136:139], v26 offset:16384
  ds_read_b128 v[140:143], v27 offset:16384
  ds_read_b128 v[152:155], v26 offset:24576
  ds_read_b128 v[156:159], v27 offset:24576
  ds_read_b128 v[168:171], v26 offset:32768
  ds_read_b128 v[172:175], v27 offset:32768
  s_mov_b64 exec, s[78:79]
  ds_write_b32 v11, v1 offset:64
  s_mov_b64 exec, -1
  v_add_u32 v24, 40960, v24
  v_add_u32 v25, 40960, v25
  v_add_u32 v26, 40960, v26
  v_add_u32 v27, 40960, v27
  s_waitcnt lgkmcnt(15)
  v_smfmac_f32_16x16x64_bf16 v[36:39], v[32:35], v[96:103], v5
  v_smfmac_f32_16x16x64_bf16 v[36:39], v[32:35], v[112:119], v5
  v_smfmac_f32_16x16x64_bf16 v[36:39], v[32:35], v[128:135], v5
  s_waitcnt lgkmcnt(13)
  v_smfmac_f32_16x16x64_bf16 v[36:39], v[32:35], v[144:151], v5
  s_waitcnt lgkmcnt(11)
  v_smfmac_f32_16x16x64_bf16 v[36:39], v[32:35], v[160:167], v5
  v_dot2c_f32_bf16 v22, v96, v96
  v_dot2c_f32_bf16 v23, v97, v97
  v_dot2c_f32_bf16 v22, v98, v98
  v_dot2c_f32_bf16 v23, v99, v99
  v_dot2c_f32_bf16 v22, v100, v100
  v_dot2c_f32_bf16 v23, v101, v101
  v_dot2c_f32_bf16 v22, v102, v102
  v_dot2c_f32_bf16 v23, v103, v103
  v_dot2c_f32_bf16 v22, v112, v112
  v_dot2c_f32_bf16 v23, v113, v113
  v_dot2c_f32_bf16 v22, v114, v114
  v_dot2c_f32_bf16 v23, v115, v115
  v_dot2c_f32_bf16 v22, v116, v116
  v_dot2c_f32_bf16 v23, v117, v117
  v_dot2c_f32_bf16 v22, v118, v118
  v_dot2c_f32_bf16 v23, v119, v119
  v_dot2c_f32_bf16 v22, v128, v128
  v_dot2c_f32_bf16 v23, v129, v129
  v_dot2c_f32_bf16 v22, v130, v130
  v_dot2c_f32_bf16 v23, v131, v131
  v_dot2c_f32_bf16 v22, v132, v132
  v_dot2c_f32_bf16 v23, v133, v133
  v_dot2c_f32_bf16 v22, v134, v134
  v_dot2c_f32_bf16 v23, v135, v135
  v_dot2c_f32_bf16 v22, v144, v144
  v_dot2c_f32_bf16 v23, v145, v145
  v_dot2c_f32_bf16 v22, v146, v146
  v_dot2c_f32_bf16 v23, v147, v147
  v_dot2c_f32_bf16 v22, v148, v148
  v_dot2c_f32_bf16 v23, v149, v149
  v_dot2c_f32_bf16 v22, v150, v150
  v_dot2c_f32_bf16 v23, v151, v151
  v_dot2c_f32_bf16 v22, v160, v160
  v_dot2c_f32_bf16 v23, v161, v161
  v_dot2c_f32_bf16 v22, v162, v162
  v_dot2c_f32_bf16 v23, v163, v163
  v_dot2c_f32_bf16 v22, v164, v164
  v_dot2c_f32_bf16 v23, v165, v165
  v_dot2c_f32_bf16 v22, v166, v166
  v_dot2c_f32_bf16 v23, v167, v167
SP_67:
  ds_read_b32 v9, v8 offset:4
  s_waitcnt lgkmcnt(0)
  v_cmp_ne_u32 vcc, 0, v9
  s_cbranch_vccz SO_68
  s_sleep 2
  s_sub_u32 s12, s12, 1
  s_cbranch_scc0 SP_67
  s_mov_b32 s12, 0
SO_68:
  ds_read_b128 v[176:179], v24 offset:0
  ds_read_b128 v[180:183], v25 offset:0
  ds_read_b128 v[192:195], v24 offset:8192
  ds_read_b128 v[196:199], v25 offset:8192
  ds_read_b128 v[208:211], v24 offset:16384
  ds_read_b128 v[212:215], v25 offset:16384
  ds_read_b128 v[224:227], v24 offset:24576
  ds_read_b128 v[228:231], v25 offset:24576
  ds_read_b128 v[240:243], v24 offset:32768
  ds_read_b128 v[244:247], v25 offset:32768
  ds_read_b128 v[184:187], v26 offset:0
  ds_read_b128 v[188:191], v27 offset:0
  ds_read_b128 v[200:203], v26 offset:8192
  ds_read_b128 v[204:207], v27 offset:8192
  ds_read_b128 v[216:219], v26 offset:16384
  ds_read_b128 v[220:223], v27 offset:16384
  ds_read_b128 v[232:235], v26 offset:24576
  ds_read_b128 v[236:239], v27 offset:24576
  ds_read_b128 v[248:251], v26 offset:32768
  ds_read_b128 v[252:255], v27 offset:32768
  s_waitcnt lgkmcnt(15)
  v_smfmac_f32_16x16x64_bf16 v[36:39], v[32:35], v[176:183], v5
  v_smfmac_f32_16x16x64_bf16 v[36:39], v[32:35], v[192:199], v5
  s_waitcnt lgkmcnt(14)
  v_smfmac_f32_16x16x64_bf16 v[36:39], v[32:35], v[208:215], v5
  s_waitcnt lgkmcnt(12)
  v_smfmac_f32_16x16x64_bf16 v[36:39], v[32:35], v[224:231], v5
  s_waitcnt lgkmcnt(10)
  v_smfmac_f32_16x16x64_bf16 v[36:39], v[32:35], v[240:247], v5
  v_dot2c_f32_bf16 v22, v176, v176
  v_dot2c_f32_bf16 v23, v177, v177
  v_dot2c_f32_bf16 v22, v178, v178
  v_dot2c_f32_bf16 v23, v179, v179
  v_dot2c_f32_bf16 v22, v180, v180
  v_dot2c_f32_bf16 v23, v181, v181
  v_dot2c_f32_bf16 v22, v182, v182
  v_dot2c_f32_bf16 v23, v183, v183
  v_dot2c_f32_bf16 v22, v192, v192
  v_dot2c_f32_bf16 v23, v193, v193
  v_dot2c_f32_bf16 v22, v194, v194
  v_dot2c_f32_bf16 v23, v195, v195
  v_dot2c_f32_bf16 v22, v196, v196
  v_dot2c_f32_bf16 v23, v197, v197
  v_dot2c_f32_bf16 v22, v198, v198
  v_dot2c_f32_bf16 v23, v199, v199
  v_dot2c_f32_bf16 v22, v208, v208
  v_dot2c_f32_bf16 v23, v209, v209
  v_dot2c_f32_bf16 v22, v210, v210
  v_dot2c_f32_bf16 v23, v211, v211
  v_dot2c_f32_bf16 v22, v212, v212
  v_dot2c_f32_bf16 v23, v213, v213
  v_dot2c_f32_bf16 v22, v214, v214
  v_dot2c_f32_bf16 v23, v215, v215
  v_dot2c_f32_bf16 v22, v224, v224
  v_dot2c_f32_bf16 v23, v225, v225
  v_dot2c_f32_bf16 v22, v226, v226
  v_dot2c_f32_bf16 v23, v227, v227
  v_dot2c_f32_bf16 v22, v228, v228
  v_dot2c_f32_bf16 v23, v229, v229
  v_dot2c_f32_bf16 v22, v230, v230
  v_dot2c_f32_bf16 v23, v231, v231
  v_dot2c_f32_bf16 v22, v240, v240
  v_dot2c_f32_bf16 v23, v241, v241
  v_dot2c_f32_bf16 v22, v242, v242
  v_dot2c_f32_bf16 v23, v243, v243
  v_dot2c_f32_bf16 v22, v244, v244
  v_dot2c_f32_bf16 v23, v245, v245
  v_dot2c_f32_bf16 v22, v246, v246
  v_dot2c_f32_bf16 v23, v247, v247
  s_nop 2
  v_add_f32 v21, v22, v23
  v_add_f32 v20, v36, v37
  v_mov_b32 v23, v21
  s_lshl_b32 s64, s61, 9
  v_add_u32 v17, s64, v30
  v_permlane32_swap_b32 v21, v23
  v_add_f32 v21, v21, v23
  ds_write_b64 v17, v[20:21] offset:0
  s_mov_b64 exec, s[78:79]
  ds_write_b32 v11, v1 offset:80
  s_mov_b64 exec, -1
  v_mov_b32 v36, 0
  v_mov_b32 v37, 0
SP_73:
  ds_read_b32 v9, v8 offset:328
  s_waitcnt lgkmcnt(0)
  v_cmp_ne_u32 vcc, 0, v9
  s_cbranch_vccz SO_74
  s_sleep 2
  s_sub_u32 s12, s12, 1
  s_cbranch_scc0 SP_73
  s_mov_b32 s12, 0
SO_74:
  ds_read_b64_tr_b16 v[44:45], v2 offset:2048
  ds_read_b64_tr_b16 v[46:47], v2 offset:2560
  ds_read_b64_tr_b16 v[40:41], v2 offset:0
  ds_read_b64_tr_b16 v[42:43], v2 offset:512
  ds_read_b64_tr_b16 v[52:53], v3 offset:2048
  ds_read_b64_tr_b16 v[54:55], v3 offset:2560
  ds_read_b64_tr_b16 v[48:49], v3 offset:0
  ds_read_b64_tr_b16 v[50:51], v3 offset:512
  s_waitcnt lgkmcnt(4)
  v_mfma_f32_32x32x16_bf16 v[64:79], v[40:43], v[96:99], 0
  ds_read_b64_tr_b16 v[60:61], v2 offset:10240
  ds_read_b64_tr_b16 v[62:63], v2 offset:10752
  ds_read_b64_tr_b16 v[56:57], v2 offset:8192
  ds_read_b64_tr_b16 v[58:59], v2 offset:8704
  v_mfma_f32_32x32x16_bf16 v[64:79], v[44:47], v[100:103], v[64:79]
  v_smfmac_f32_16x16x64_bf16 v[36:39], v[32:35], v[40:47], v5
  s_waitcnt lgkmcnt(4)
  v_mfma_f32_32x32x16_bf16 v[64:79], v[48:51], v[104:107], v[64:79]
  ds_read_b64_tr_b16 v[44:45], v3 offset:10240
  ds_read_b64_tr_b16 v[46:47], v3 offset:10752
  ds_read_b64_tr_b16 v[40:41], v3 offset:8192
  ds_read_b64_tr_b16 v[42:43], v3 offset:8704
  v_mfma_f32_32x32x16_bf16 v[64:79], v[52:55], v[108:111], v[64:79]
  s_setprio 2
  ds_read_b32 v19, v11 offset:80
  ds_read_b64 v[20:21], v30 offset:0
  ds_read_b64 v[22:23], v30 offset:512
  v_smfmac_f32_16x16x64_bf16 v[36:39], v[32:35], v[48:55], v5
  s_waitcnt lgkmcnt(7)
  v_mfma_f32_32x32x16_bf16 v[64:79], v[56:59], v[112:115], v[64:79]
  ds_read_b64_tr_b16 v[52:53], v2 offset:18432
  ds_read_b64_tr_b16 v[54:55], v2 offset:18944
  ds_read_b64_tr_b16 v[48:49], v2 offset:16384
  ds_read_b64_tr_b16 v[50:51], v2 offset:16896
  v_mfma_f32_32x32x16_bf16 v[64:79], v[60:63], v[116:119], v[64:79]
  s_waitcnt lgkmcnt(6)
  v_cmp_ne_u32 vcc, 0, v19
  s_cbranch_vccnz SL_69
BK_70:
  s_waitcnt lgkmcnt(4)
  v_add_f32 v20, v20, v22
  v_add_f32 v21, v21, v23
  v_mul_f32 v24, 0x3acccccd, v20
  v_mul_f32 v25, 0x3acccccd, v21
  v_smfmac_f32_16x16x64_bf16 v[36:39], v[32:35], v[56:63], v5
  v_fma_f32 v25, -v24, v24, v25
  v_mfma_f32_32x32x16_bf16 v[64:79], v[40:43], v[120:123], v[64:79]
  ds_read_b64_tr_b16 v[60:61], v3 offset:18432
  ds_read_b64_tr_b16 v[62:63], v3 offset:18944
  ds_read_b64_tr_b16 v[56:57], v3 offset:16384
  ds_read_b64_tr_b16 v[58:59], v3 offset:16896
  v_mfma_f32_32x32x16_bf16 v[64:79], v[44:47], v[124:127], v[64:79]
  v_max_f32 v25, 0, v25
  v_cvt_pk_bf16_f32 v26, 0, v24
  v_cvt_pk_bf16_f32 v27, 0, v25
  v_add_f32 v27, 0x3727c5ac, v27
  v_cvt_pk_bf16_f32 v27, 0, v27
  v_smfmac_f32_16x16x64_bf16 v[36:39], v[32:35], v[40:47], v5
  v_sqrt_f32 v27, v27
  s_waitcnt lgkmcnt(4)
  v_mfma_f32_32x32x16_bf16 v[64:79], v[48:51], v[128:131], v[64:79]
  ds_read_b32 v9, v8 offset:8
  ds_read_b64_tr_b16 v[44:45], v2 offset:26624
  ds_read_b64_tr_b16 v[46:47], v2 offset:27136
  ds_read_b64_tr_b16 v[40:41], v2 offset:24576
  ds_read_b64_tr_b16 v[42:43], v2 offset:25088
  v_mfma_f32_32x32x16_bf16 v[64:79], v[52:55], v[132:135], v[64:79]
  v_cvt_pk_bf16_f32 v27, 0, v27
  v_rcp_f32 v28, v27
  v_sub_f32 v24, v24, v26
  v_mul_f32 v24, v24, v28
  v_mul_f32 v25, v25, v28
  v_smfmac_f32_16x16x64_bf16 v[36:39], v[32:35], v[48:55], v5
  v_mul_f32 v25, v25, v28
  s_waitcnt lgkmcnt(5)
  v_mfma_f32_32x32x16_bf16 v[64:79], v[56:59], v[136:139], v[64:79]
  s_waitcnt lgkmcnt(4)
  v_cmp_ne_u32 vcc, 0, v9
  s_cbranch_vccnz SL_79
BK_80:
  ds_read_b64_tr_b16 v[52:53], v3 offset:26624
  ds_read_b64_tr_b16 v[54:55], v3 offset:27136
  ds_read_b64_tr_b16 v[48:49], v3 offset:24576
  ds_read_b64_tr_b16 v[50:51], v3 offset:25088
  v_mfma_f32_32x32x16_bf16 v[64:79], v[60:63], v[140:143], v[64:79]
  v_cvt_pk_bf16_f32 v24, 0, v24
  v_cvt_pk_bf16_f32 v25, 0, v25
  v_add_f32 v25, 0x3727c5ac, v25
  v_cvt_pk_bf16_f32 v25, 0, v25
  v_smfmac_f32_16x16x64_bf16 v[36:39], v[32:35], v[56:63], v5
  v_sqrt_f32 v25, v25
  s_waitcnt lgkmcnt(4)
  v_mfma_f32_32x32x16_bf16 v[64:79], v[40:43], v[144:147], v[64:79]
  ds_read_b64_tr_b16 v[60:61], v2 offset:34816
  ds_read_b64_tr_b16 v[62:63], v2 offset:35328
  ds_read_b64_tr_b16 v[56:57], v2 offset:32768
  ds_read_b64_tr_b16 v[58:59], v2 offset:33280
  v_mfma_f32_32x32x16_bf16 v[64:79], v[44:47], v[148:151], v[64:79]
  v_fma_f32 v28, -v24, v27, -v26
  v_cvt_pk_bf16_f32 v25, 0, v25
  v_mul_f32 v29, v25, v27
  v_mov_b32 v10, v29
  v_rcp_f32 v20, v29
  v_smfmac_f32_16x16x64_bf16 v[36:39], v[32:35], v[40:47], v5
  v_cvt_pk_bf16_f32 v21, 0, v28
  s_waitcnt lgkmcnt(4)
  v_mfma_f32_32x32x16_bf16 v[64:79], v[48:51], v[152:155], v[64:79]
  ds_read_b64_tr_b16 v[44:45], v3 offset:34816
  ds_read_b64_tr_b16 v[46:47], v3 offset:35328
  ds_read_b64_tr_b16 v[40:41], v3 offset:32768
  ds_read_b64_tr_b16 v[42:43], v3 offset:33280
  v_mfma_f32_32x32x16_bf16 v[64:79], v[52:55], v[156:159], v[64:79]
  s_mov_b64 exec, s[78:79]
  ds_write_b32 v11, v1 offset:96
  s_mov_b64 exec, -1
  v_subrev_u32 v2, 81920, v2
  v_subrev_u32 v3, 81920, v3
  v_smfmac_f32_16x16x64_bf16 v[36:39], v[32:35], v[48:55], v5
  v_cvt_pk_bf16_f32 v22, 0, v29
  s_waitcnt lgkmcnt(5)
  v_mfma_f32_32x32x16_bf16 v[64:79], v[56:59], v[160:163], v[64:79]
  ds_read_b32 v9, v8 offset:332
  ds_read_b64_tr_b16 v[52:53], v2 offset:2048
  ds_read_b64_tr_b16 v[54:55], v2 offset:2560
  ds_read_b64_tr_b16 v[48:49], v2 offset:0
  ds_read_b64_tr_b16 v[50:51], v2 offset:512
  v_mfma_f32_32x32x16_bf16 v[64:79], v[60:63], v[164:167], v[64:79]
  v_sub_f32 v23, v28, v21
  v_sub_f32 v24, v29, v22
  v_cvt_pk_bf16_f32 v25, v21, v23
  v_cvt_pk_bf16_f32 v26, v21, v22
  v_cvt_pk_bf16_f32 v27, v24, 0
  v_cndmask_b32 v16, 0, v25, s[70:71]
  v_smfmac_f32_16x16x64_bf16 v[36:39], v[32:35], v[56:63], v5
  v_cndmask_b32 v17, 0, v26, s[70:71]
  s_waitcnt lgkmcnt(6)
  v_mfma_f32_32x32x16_bf16 v[64:79], v[40:43], v[168:171], v[64:79]
  s_waitcnt lgkmcnt(4)
  v_cmp_ne_u32 vcc, 0, v9
  s_cbranch_vccnz SL_83
BK_84:
  ds_read_b64_tr_b16 v[60:61], v3 offset:2048
  ds_read_b64_tr_b16 v[62:63], v3 offset:2560
  ds_read_b64_tr_b16 v[56:57], v3 offset:0
  ds_read_b64_tr_b16 v[58:59], v3 offset:512
  v_mfma_f32_32x32x16_bf16 v[64:79], v[44:47], v[172:175], v[64:79]
  v_cndmask_b32 v18, 0, v27, s[70:71]
  v_mov_b32 v19, 0
  v_mul_f32 v6, 0xc0135761, v20
  v_mul_f32 v20, v20, v20
  v_mul_f32 v20, 0x3d372713, v20
  v_mul_f32 v7, v20, v6
  v_smfmac_f32_16x16x64_bf16 v[36:39], v[32:35], v[40:47], v5
  v_mov_b32 v23, 0
  s_waitcnt lgkmcnt(4)
  v_mfma_f32_32x32x16_bf16 v[64:79], v[48:51], v[176:179], v[64:79]
  ds_read_b64_tr_b16 v[44:45], v2 offset:10240
  ds_read_b64_tr_b16 v[46:47], v2 offset:10752
  ds_read_b64_tr_b16 v[40:41], v2 offset:8192
  ds_read_b64_tr_b16 v[42:43], v2 offset:8704
  v_mfma_f32_32x32x16_bf16 v[64:79], v[52:55], v[180:183], v[64:79]
  v_smfmac_f32_16x16x64_bf16 v[36:39], v[32:35], v[48:55], v5
  s_waitcnt lgkmcnt(4)
  v_mfma_f32_32x32x16_bf16 v[64:79], v[56:59], v[184:187], v[64:79]
  ds_read_b64_tr_b16 v[52:53], v3 offset:10240
  ds_read_b64_tr_b16 v[54:55], v3 offset:10752
  ds_read_b64_tr_b16 v[48:49], v3 offset:8192
  ds_read_b64_tr_b16 v[50:51], v3 offset:8704
  v_mfma_f32_32x32x16_bf16 v[64:79], v[60:63], v[188:191], v[64:79]
  v_and_b32 v29, 7, v0
  v_lshlrev_b32 v29, 2, v29
  global_load_dword v28, v29, s[42:43] sc1
  v_smfmac_f32_16x16x64_bf16 v[36:39], v[32:35], v[56:63], v5
  s_waitcnt lgkmcnt(4)
  v_mfma_f32_32x32x16_bf16 v[64:79], v[40:43], v[192:195], v[64:79]
  ds_read_b64_tr_b16 v[60:61], v2 offset:18432
  ds_read_b64_tr_b16 v[62:63], v2 offset:18944
  ds_read_b64_tr_b16 v[56:57], v2 offset:16384
  ds_read_b64_tr_b16 v[58:59], v2 offset:16896
  v_mfma_f32_32x32x16_bf16 v[64:79], v[44:47], v[196:199], v[64:79]
  v_smfmac_f32_16x16x64_bf16 v[36:39], v[32:35], v[40:47], v5
  s_waitcnt lgkmcnt(4)
  v_mfma_f32_32x32x16_bf16 v[64:79], v[48:51], v[200:203], v[64:79]
  ds_read_b64_tr_b16 v[44:45], v3 offset:18432
  ds_read_b64_tr_b16 v[46:47], v3 offset:18944
  ds_read_b64_tr_b16 v[40:41], v3 offset:16384
  ds_read_b64_tr_b16 v[42:43], v3 offset:16896
  v_mfma_f32_32x32x16_bf16 v[64:79], v[52:55], v[204:207], v[64:79]
  v_smfmac_f32_16x16x64_bf16 v[36:39], v[32:35], v[48:55], v5
  s_waitcnt lgkmcnt(4)
  v_mfma_f32_32x32x16_bf16 v[64:79], v[56:59], v[208:211], v[64:79]
  ds_read_b32 v9, v8 offset:12
  ds_read_b64_tr_b16 v[52:53], v2 offset:26624
  ds_read_b64_tr_b16 v[54:55], v2 offset:27136
  ds_read_b64_tr_b16 v[48:49], v2 offset:24576
  ds_read_b64_tr_b16 v[50:51], v2 offset:25088
  v_mfma_f32_32x32x16_bf16 v[64:79], v[60:63], v[212:215], v[64:79]
  v_smfmac_f32_16x16x64_bf16 v[36:39], v[32:35], v[56:63], v5
  s_waitcnt lgkmcnt(5)
  v_mfma_f32_32x32x16_bf16 v[64:79], v[40:43], v[216:219], v[64:79]
  s_waitcnt lgkmcnt(4)
  v_cmp_ne_u32 vcc, 0, v9
  s_cbranch_vccnz SL_87
BK_88:
  ds_read_b64_tr_b16 v[60:61], v3 offset:26624
  ds_read_b64_tr_b16 v[62:63], v3 offset:27136
  ds_read_b64_tr_b16 v[56:57], v3 offset:24576
  ds_read_b64_tr_b16 v[58:59], v3 offset:25088
  v_mfma_f32_32x32x16_bf16 v[64:79], v[44:47], v[220:223], v[64:79]
  v_smfmac_f32_16x16x64_bf16 v[36:39], v[32:35], v[40:47], v5
  s_waitcnt lgkmcnt(4)
  v_mfma_f32_32x32x16_bf16 v[64:79], v[48:51], v[224:227], v[64:79]
  ds_read_b64_tr_b16 v[44:45], v2 offset:34816
  ds_read_b64_tr_b16 v[46:47], v2 offset:35328
  ds_read_b64_tr_b16 v[40:41], v2 offset:32768
  ds_read_b64_tr_b16 v[42:43], v2 offset:33280
  v_mfma_f32_32x32x16_bf16 v[64:79], v[52:55], v[228:231], v[64:79]
  v_smfmac_f32_16x16x64_bf16 v[36:39], v[32:35], v[48:55], v5
  s_waitcnt lgkmcnt(4)
  v_mfma_f32_32x32x16_bf16 v[64:79], v[56:59], v[232:235], v[64:79]
  ds_read_b64_tr_b16 v[52:53], v3 offset:34816
  ds_read_b64_tr_b16 v[54:55], v3 offset:35328
  ds_read_b64_tr_b16 v[48:49], v3 offset:32768
  ds_read_b64_tr_b16 v[50:51], v3 offset:33280
  v_mfma_f32_32x32x16_bf16 v[64:79], v[60:63], v[236:239], v[64:79]
  s_mov_b64 exec, s[78:79]
  ds_write_b32 v11, v1 offset:112
  s_mov_b64 exec, -1
  v_add_u32 v2, 40960, v2
  v_add_u32 v3, 40960, v3
  v_smfmac_f32_16x16x64_bf16 v[36:39], v[32:35], v[56:63], v5
  s_waitcnt lgkmcnt(5)
  v_mfma_f32_32x32x16_bf16 v[64:79], v[40:43], v[240:243], v[64:79]
  ds_read_b32 v9, v8 offset:336
  ds_read_b64_tr_b16 v[60:61], v2 offset:2048
  ds_read_b64_tr_b16 v[62:63], v2 offset:2560
  ds_read_b64_tr_b16 v[56:57], v2 offset:0
  ds_read_b64_tr_b16 v[58:59], v2 offset:512
  v_mfma_f32_32x32x16_bf16 v[64:79], v[44:47], v[244:247], v[64:79]
  v_smfmac_f32_16x16x64_bf16 v[36:39], v[32:35], v[40:47], v5
  s_waitcnt lgkmcnt(6)
  v_smfmac_f32_16x16x64_bf16 v[36:39], v[32:35], v[48:55], v5
  v_mfma_f32_32x32x16_bf16 v[64:79], v[48:51], v[248:251], v[64:79]
  s_waitcnt lgkmcnt(4)
  v_cmp_ne_u32 vcc, 0, v9
  s_cbranch_vccnz SL_91
BK_92:
  ds_read_b64_tr_b16 v[44:45], v3 offset:2048
  ds_read_b64_tr_b16 v[46:47], v3 offset:2560
  ds_read_b64_tr_b16 v[40:41], v3 offset:0
  ds_read_b64_tr_b16 v[42:43], v3 offset:512
  v_mfma_f32_32x32x16_bf16 v[64:79], v[52:55], v[252:255], v[64:79]
  s_waitcnt lgkmcnt(4)
  v_mfma_f32_32x32x16_bf16 v[80:95], v[56:59], v[96:99], 0
  ds_read_b64_tr_b16 v[52:53], v2 offset:10240
  ds_read_b64_tr_b16 v[54:55], v2 offset:10752
  ds_read_b64_tr_b16 v[48:49], v2 offset:8192
  ds_read_b64_tr_b16 v[50:51], v2 offset:8704
  v_mfma_f32_32x32x16_bf16 v[80:95], v[60:63], v[100:103], v[80:95]
  s_waitcnt vmcnt(4)
  v_cvt_pk_bf16_f32 v22, v12, 0
  v_add_f32 v24, v36, v37
  v_mov_b32 v36, 0
  v_mov_b32 v37, 0
  v_cvt_pk_bf16_f32 v20, v24, v24
  v_and_b32 v25, 0xffff0000, v20
  v_sub_f32 v24, v24, v25
  v_cvt_pk_bf16_f32 v21, v24, v12
  s_nop 1
  v_mfma_f32_32x32x16_bf16 v[64:79], v[20:23], v[16:19], v[64:79]
  v_smfmac_f32_16x16x64_bf16 v[36:39], v[32:35], v[56:63], v5
  s_waitcnt lgkmcnt(4)
  v_mfma_f32_32x32x16_bf16 v[80:95], v[40:43], v[104:107], v[80:95]
  ds_read_b64_tr_b16 v[60:61], v3 offset:10240
  ds_read_b64_tr_b16 v[62:63], v3 offset:10752
  ds_read_b64_tr_b16 v[56:57], v3 offset:8192
  ds_read_b64_tr_b16 v[58:59], v3 offset:8704
  v_mfma_f32_32x32x16_bf16 v[80:95], v[44:47], v[108:111], v[80:95]
  s_waitcnt vmcnt(0)
  v_cmp_eq_u32 vcc, 0, v28
  s_cbranch_vccnz SL_75
BK_76:
  v_smfmac_f32_16x16x64_bf16 v[36:39], v[32:35], v[40:47], v5
  s_waitcnt lgkmcnt(4)
  v_mfma_f32_32x32x16_bf16 v[80:95], v[48:51], v[112:115], v[80:95]
  ds_read_b64_tr_b16 v[44:45], v2 offset:18432
  ds_read_b64_tr_b16 v[46:47], v2 offset:18944
  ds_read_b64_tr_b16 v[40:41], v2 offset:16384
  ds_read_b64_tr_b16 v[42:43], v2 offset:16896
  v_mfma_f32_32x32x16_bf16 v[80:95], v[52:55], v[116:119], v[80:95]
  v_mul_f32 v24, v64, v64
  v_mul_f32 v25, v65, v65
  v_mul_f32 v26, v66, v66
  v_mul_f32 v27, v67, v67
  v_fma_f32 v24, v24, v7, v6
  v_fma_f32 v25, v25, v7, v6
  v_fma_f32 v26, v26, v7, v6
  v_fma_f32 v27, v27, v7, v6
  v_mul_f32 v24, v24, v64
  v_mul_f32 v25, v25, v65
  v_smfmac_f32_16x16x64_bf16 v[36:39], v[32:35], v[48:55], v5
  v_mul_f32 v26, v26, v66
  v_mul_f32 v27, v27, v67
  s_waitcnt lgkmcnt(4)
  v_mfma_f32_32x32x16_bf16 v[80:95], v[56:59], v[120:123], v[80:95]
  ds_read_b64_tr_b16 v[52:53], v3 offset:18432
  ds_read_b64_tr_b16 v[54:55], v3 offset:18944
  ds_read_b64_tr_b16 v[48:49], v3 offset:16384
  ds_read_b64_tr_b16 v[50:51], v3 offset:16896
  v_mfma_f32_32x32x16_bf16 v[80:95], v[60:63], v[124:127], v[80:95]
  v_exp_f32 v24, v24
  v_exp_f32 v25, v25
  v_exp_f32 v26, v26
  v_exp_f32 v27, v27
  v_fma_f32 v24, v24, v10, v10
  v_fma_f32 v25, v25, v10, v10
  v_fma_f32 v26, v26, v10, v10
  v_smfmac_f32_16x16x64_bf16 v[36:39], v[32:35], v[56:63], v5
  v_fma_f32 v27, v27, v10, v10
  v_rcp_f32 v24, v24
  s_waitcnt lgkmcnt(4)
  v_mfma_f32_32x32x16_bf16 v[80:95], v[40:43], v[128:131], v[80:95]
  ds_read_b32 v9, v8 offset:16
  ds_read_b64_tr_b16 v[60:61], v2 offset:26624
  ds_read_b64_tr_b16 v[62:63], v2 offset:27136
  ds_read_b64_tr_b16 v[56:57], v2 offset:24576
  ds_read_b64_tr_b16 v[58:59], v2 offset:25088
  v_mfma_f32_32x32x16_bf16 v[80:95], v[44:47], v[132:135], v[80:95]
  v_rcp_f32 v25, v25
  v_rcp_f32 v26, v26
  v_rcp_f32 v27, v27
  v_mul_f32 v24, v24, v64
  v_mul_f32 v25, v25, v65
  v_mul_f32 v26, v26, v66
  v_mul_f32 v27, v27, v67
  v_smfmac_f32_16x16x64_bf16 v[36:39], v[32:35], v[40:47], v5
  v_cvt_pk_bf16_f32 v28, v24, v25
  v_cvt_pk_bf16_f32 v29, v26, v27
  s_waitcnt lgkmcnt(5)
  v_mfma_f32_32x32x16_bf16 v[80:95], v[48:51], v[136:139], v[80:95]
  s_waitcnt lgkmcnt(4)
  v_cmp_ne_u32 vcc, 0, v9
  s_cbranch_vccnz SL_95
BK_96:
  ds_read_b64_tr_b16 v[44:45], v3 offset:26624
  ds_read_b64_tr_b16 v[46:47], v3 offset:27136
  ds_read_b64_tr_b16 v[40:41], v3 offset:24576
  ds_read_b64_tr_b16 v[42:43], v3 offset:25088
  v_mfma_f32_32x32x16_bf16 v[80:95], v[52:55], v[140:143], v[80:95]
  v_mul_f32 v24, v68, v68
  v_mul_f32 v25, v69, v69
  v_mul_f32 v26, v70, v70
  v_mul_f32 v27, v71, v71
  v_fma_f32 v24, v24, v7, v6
  v_fma_f32 v25, v25, v7, v6
  v_fma_f32 v26, v26, v7, v6
  v_fma_f32 v27, v27, v7, v6
  v_mul_f32 v24, v24, v68
  v_mul_f32 v25, v25, v69
  v_smfmac_f32_16x16x64_bf16 v[36:39], v[32:35], v[48:55], v5
  v_mul_f32 v26, v26, v70
  v_mul_f32 v27, v27, v71
  s_waitcnt lgkmcnt(4)
  v_mfma_f32_32x32x16_bf16 v[80:95], v[56:59], v[144:147], v[80:95]
  ds_read_b64_tr_b16 v[52:53], v2 offset:34816
  ds_read_b64_tr_b16 v[54:55], v2 offset:35328
  ds_read_b64_tr_b16 v[48:49], v2 offset:32768
  ds_read_b64_tr_b16 v[50:51], v2 offset:33280
  v_mfma_f32_32x32x16_bf16 v[80:95], v[60:63], v[148:151], v[80:95]
  v_exp_f32 v24, v24
  v_exp_f32 v25, v25
  v_exp_f32 v26, v26
  v_exp_f32 v27, v27
  v_fma_f32 v24, v24, v10, v10
  v_fma_f32 v25, v25, v10, v10
  v_fma_f32 v26, v26, v10, v10
  v_smfmac_f32_16x16x64_bf16 v[36:39], v[32:35], v[56:63], v5
  v_fma_f32 v27, v27, v10, v10
  v_rcp_f32 v24, v24
  s_waitcnt lgkmcnt(4)
  v_mfma_f32_32x32x16_bf16 v[80:95], v[40:43], v[152:155], v[80:95]
  ds_read_b64_tr_b16 v[60:61], v3 offset:34816
  ds_read_b64_tr_b16 v[62:63], v3 offset:35328
  ds_read_b64_tr_b16 v[56:57], v3 offset:32768
  ds_read_b64_tr_b16 v[58:59], v3 offset:33280
  v_mfma_f32_32x32x16_bf16 v[80:95], v[44:47], v[156:159], v[80:95]
  s_mov_b64 exec, s[78:79]
  ds_write_b32 v11, v1 offset:128
  s_mov_b64 exec, -1
  v_add_u32 v2, 40960, v2
  v_add_u32 v3, 40960, v3
  v_smfmac_f32_16x16x64_bf16 v[36:39], v[32:35], v[40:47], v5
  v_rcp_f32 v25, v25
  s_waitcnt lgkmcnt(5)
  v_mfma_f32_32x32x16_bf16 v[80:95], v[48:51], v[160:163], v[80:95]
  ds_read_b32 v9, v8 offset:340
  ds_read_b64_tr_b16 v[44:45], v2 offset:2048
  ds_read_b64_tr_b16 v[46:47], v2 offset:2560
  ds_read_b64_tr_b16 v[40:41], v2 offset:0
  ds_read_b64_tr_b16 v[42:43], v2 offset:512
  v_mfma_f32_32x32x16_bf16 v[80:95], v[52:55], v[164:167], v[80:95]
  v_rcp_f32 v26, v26
  v_rcp_f32 v27, v27
  v_mul_f32 v24, v24, v68
  v_mul_f32 v25, v25, v69
  v_mul_f32 v26, v26, v70
  v_mul_f32 v27, v27, v71
  v_cvt_pk_bf16_f32 v30, v24, v25
  v_cvt_pk_bf16_f32 v31, v26, v27
  v_smfmac_f32_16x16x64_bf16 v[36:39], v[32:35], v[48:55], v5
  buffer_store_dwordx4 v[28:31], v4, s[48:51], s55 offen offset:0 sc1
  v_mul_f32 v24, v72, v72
  s_waitcnt lgkmcnt(6)
  v_mfma_f32_32x32x16_bf16 v[80:95], v[56:59], v[168:171], v[80:95]
  s_waitcnt lgkmcnt(4)
  v_cmp_ne_u32 vcc, 0, v9
  s_cbranch_vccnz SL_99
BK_100:
  ds_read_b64_tr_b16 v[52:53], v3 offset:2048
  ds_read_b64_tr_b16 v[54:55], v3 offset:2560
  ds_read_b64_tr_b16 v[48:49], v3 offset:0
  ds_read_b64_tr_b16 v[50:51], v3 offset:512
  v_mfma_f32_32x32x16_bf16 v[80:95], v[60:63], v[172:175], v[80:95]
  v_mul_f32 v25, v73, v73
  v_mul_f32 v26, v74, v74
  v_mul_f32 v27, v75, v75
  v_fma_f32 v24, v24, v7, v6
  v_fma_f32 v25, v25, v7, v6
  v_fma_f32 v26, v26, v7, v6
  v_fma_f32 v27, v27, v7, v6
  v_mul_f32 v24, v24, v72
  v_mul_f32 v25, v25, v73
  v_mul_f32 v26, v26, v74
  v_smfmac_f32_16x16x64_bf16 v[36:39], v[32:35], v[56:63], v5
  v_mul_f32 v27, v27, v75
  v_exp_f32 v24, v24
  s_waitcnt lgkmcnt(4)
  v_mfma_f32_32x32x16_bf16 v[80:95], v[40:43], v[176:179], v[80:95]
  ds_read_b64_tr_b16 v[60:61], v2 offset:10240
  ds_read_b64_tr_b16 v[62:63], v2 offset:10752
  ds_read_b64_tr_b16 v[56:57], v2 offset:8192
  ds_read_b64_tr_b16 v[58:59], v2 offset:8704
  v_mfma_f32_32x32x16_bf16 v[80:95], v[44:47], v[180:183], v[80:95]
  v_exp_f32 v25, v25
  v_exp_f32 v26, v26
  v_exp_f32 v27, v27
  v_fma_f32 v24, v24, v10, v10
  v_fma_f32 v25, v25, v10, v10
  v_fma_f32 v26, v26, v10, v10
  v_fma_f32 v27, v27, v10, v10
  v_smfmac_f32_16x16x64_bf16 v[36:39], v[32:35], v[40:47], v5
  v_rcp_f32 v24, v24
  s_waitcnt lgkmcnt(4)
  v_mfma_f32_32x32x16_bf16 v[80:95], v[48:51], v[184:187], v[80:95]
  ds_read_b64_tr_b16 v[44:45], v3 offset:10240
  ds_read_b64_tr_b16 v[46:47], v3 offset:10752
  ds_read_b64_tr_b16 v[40:41], v3 offset:8192
  ds_read_b64_tr_b16 v[42:43], v3 offset:8704
  v_mfma_f32_32x32x16_bf16 v[80:95], v[52:55], v[188:191], v[80:95]
  v_rcp_f32 v25, v25
  v_rcp_f32 v26, v26
  v_rcp_f32 v27, v27
  v_mul_f32 v24, v24, v72
  v_mul_f32 v25, v25, v73
  v_mul_f32 v26, v26, v74
  v_mul_f32 v27, v27, v75
  v_cvt_pk_bf16_f32 v28, v24, v25
  v_smfmac_f32_16x16x64_bf16 v[36:39], v[32:35], v[48:55], v5
  v_cvt_pk_bf16_f32 v29, v26, v27
  v_mul_f32 v24, v76, v76
  v_mul_f32 v25, v77, v77
  s_waitcnt lgkmcnt(4)
  v_mfma_f32_32x32x16_bf16 v[80:95], v[56:59], v[192:195], v[80:95]
  ds_read_b64_tr_b16 v[52:53], v2 offset:18432
  ds_read_b64_tr_b16 v[54:55], v2 offset:18944
  ds_read_b64_tr_b16 v[48:49], v2 offset:16384
  ds_read_b64_tr_b16 v[50:51], v2 offset:16896
  v_mfma_f32_32x32x16_bf16 v[80:95], v[60:63], v[196:199], v[80:95]
  v_mul_f32 v26, v78, v78
  v_mul_f32 v27, v79, v79
  v_fma_f32 v24, v24, v7, v6
  v_fma_f32 v25, v25, v7, v6
  v_fma_f32 v26, v26, v7, v6
  v_fma_f32 v27, v27, v7, v6
  v_mul_f32 v24, v24, v76
  v_mul_f32 v25, v25, v77
  v_mul_f32 v26, v26, v78
  v_smfmac_f32_16x16x64_bf16 v[36:39], v[32:35], v[56:63], v5
  v_mul_f32 v27, v27, v79
  v_exp_f32 v24, v24
  s_waitcnt lgkmcnt(4)
  v_mfma_f32_32x32x16_bf16 v[80:95], v[40:43], v[200:203], v[80:95]
  ds_read_b64_tr_b16 v[60:61], v3 offset:18432
  ds_read_b64_tr_b16 v[62:63], v3 offset:18944
  ds_read_b64_tr_b16 v[56:57], v3 offset:16384
  ds_read_b64_tr_b16 v[58:59], v3 offset:16896
  v_mfma_f32_32x32x16_bf16 v[80:95], v[44:47], v[204:207], v[80:95]
  v_exp_f32 v25, v25
  v_exp_f32 v26, v26
  v_exp_f32 v27, v27
  v_fma_f32 v24, v24, v10, v10
  v_fma_f32 v25, v25, v10, v10
  v_fma_f32 v26, v26, v10, v10
  v_fma_f32 v27, v27, v10, v10
  v_smfmac_f32_16x16x64_bf16 v[36:39], v[32:35], v[40:47], v5
  v_rcp_f32 v24, v24
  s_waitcnt lgkmcnt(4)
  v_mfma_f32_32x32x16_bf16 v[80:95], v[48:51], v[208:211], v[80:95]
  ds_read_b32 v9, v8 offset:20
  ds_read_b64_tr_b16 v[44:45], v2 offset:26624
  ds_read_b64_tr_b16 v[46:47], v2 offset:27136
  ds_read_b64_tr_b16 v[40:41], v2 offset:24576
  ds_read_b64_tr_b16 v[42:43], v2 offset:25088
  v_mfma_f32_32x32x16_bf16 v[80:95], v[52:55], v[212:215], v[80:95]
  v_rcp_f32 v25, v25
  v_rcp_f32 v26, v26
  v_rcp_f32 v27, v27
  v_mul_f32 v24, v24, v76
  v_mul_f32 v25, v25, v77
  v_mul_f32 v26, v26, v78
  v_mul_f32 v27, v27, v79
  v_cvt_pk_bf16_f32 v30, v24, v25
  v_smfmac_f32_16x16x64_bf16 v[36:39], v[32:35], v[48:55], v5
  v_cvt_pk_bf16_f32 v31, v26, v27
  buffer_store_dwordx4 v[28:31], v4, s[48:51], s55 offen offset:512 sc1
  s_waitcnt lgkmcnt(5)
  v_mfma_f32_32x32x16_bf16 v[80:95], v[56:59], v[216:219], v[80:95]
  s_waitcnt lgkmcnt(4)
  v_cmp_ne_u32 vcc, 0, v9
  s_cbranch_vccnz SL_103
BK_104:
  ds_read_b64_tr_b16 v[52:53], v3 offset:26624
  ds_read_b64_tr_b16 v[54:55], v3 offset:27136
  ds_read_b64_tr_b16 v[48:49], v3 offset:24576
  ds_read_b64_tr_b16 v[50:51], v3 offset:25088
  v_mfma_f32_32x32x16_bf16 v[80:95], v[60:63], v[220:223], v[80:95]
  v_smfmac_f32_16x16x64_bf16 v[36:39], v[32:35], v[56:63], v5
  s_waitcnt lgkmcnt(4)
  v_mfma_f32_32x32x16_bf16 v[80:95], v[40:43], v[224:227], v[80:95]
  ds_read_b64_tr_b16 v[60:61], v2 offset:34816
  ds_read_b64_tr_b16 v[62:63], v2 offset:35328
  ds_read_b64_tr_b16 v[56:57], v2 offset:32768
  ds_read_b64_tr_b16 v[58:59], v2 offset:33280
  v_mfma_f32_32x32x16_bf16 v[80:95], v[44:47], v[228:231], v[80:95]
  v_smfmac_f32_16x16x64_bf16 v[36:39], v[32:35], v[40:47], v5
  s_waitcnt lgkmcnt(4)
  v_mfma_f32_32x32x16_bf16 v[80:95], v[48:51], v[232:235], v[80:95]
  ds_read_b64_tr_b16 v[44:45], v3 offset:34816
  ds_read_b64_tr_b16 v[46:47], v3 offset:35328
  ds_read_b64_tr_b16 v[40:41], v3 offset:32768
  ds_read_b64_tr_b16 v[42:43], v3 offset:33280
  v_mfma_f32_32x32x16_bf16 v[80:95], v[52:55], v[236:239], v[80:95]
  s_mov_b64 exec, s[78:79]
  ds_write_b32 v11, v1 offset:144
  s_mov_b64 exec, -1
  v_subrev_u32 v2, 81920, v2
  v_subrev_u32 v3, 81920, v3
  v_smfmac_f32_16x16x64_bf16 v[36:39], v[32:35], v[48:55], v5
  s_waitcnt lgkmcnt(5)
  v_mfma_f32_32x32x16_bf16 v[80:95], v[56:59], v[240:243], v[80:95]
  ds_read_b32 v9, v8 offset:344
  ds_read_b64_tr_b16 v[52:53], v2 offset:2048
  ds_read_b64_tr_b16 v[54:55], v2 offset:2560
  ds_read_b64_tr_b16 v[48:49], v2 offset:0
  ds_read_b64_tr_b16 v[50:51], v2 offset:512
  v_mfma_f32_32x32x16_bf16 v[80:95], v[60:63], v[244:247], v[80:95]
  v_smfmac_f32_16x16x64_bf16 v[36:39], v[32:35], v[56:63], v5
  s_waitcnt lgkmcnt(6)
  v_smfmac_f32_16x16x64_bf16 v[36:39], v[32:35], v[40:47], v5
  v_mfma_f32_32x32x16_bf16 v[80:95], v[40:43], v[248:251], v[80:95]
  s_waitcnt lgkmcnt(4)
  v_cmp_ne_u32 vcc, 0, v9
  s_cbranch_vccnz SL_107
BK_108:
  ds_read_b64_tr_b16 v[60:61], v3 offset:2048
  ds_read_b64_tr_b16 v[62:63], v3 offset:2560
  ds_read_b64_tr_b16 v[56:57], v3 offset:0
  ds_read_b64_tr_b16 v[58:59], v3 offset:512
  v_mfma_f32_32x32x16_bf16 v[80:95], v[44:47], v[252:255], v[80:95]
  s_waitcnt lgkmcnt(4)
  v_mfma_f32_32x32x16_bf16 v[64:79], v[48:51], v[96:99], 0
  ds_read_b64_tr_b16 v[44:45], v2 offset:10240
  ds_read_b64_tr_b16 v[46:47], v2 offset:10752
  ds_read_b64_tr_b16 v[40:41], v2 offset:8192
  ds_read_b64_tr_b16 v[42:43], v2 offset:8704
  v_mfma_f32_32x32x16_bf16 v[64:79], v[52:55], v[100:103], v[64:79]
  v_cvt_pk_bf16_f32 v22, v13, 0
  v_add_f32 v24, v36, v37
  v_mov_b32 v36, 0
  v_mov_b32 v37, 0
  v_cvt_pk_bf16_f32 v20, v24, v24
  v_and_b32 v25, 0xffff0000, v20
  v_sub_f32 v24, v24, v25
  v_cvt_pk_bf16_f32 v21, v24, v13
  s_nop 1
  v_mfma_f32_32x32x16_bf16 v[80:95], v[20:23], v[16:19], v[80:95]
  v_smfmac_f32_16x16x64_bf16 v[36:39], v[32:35], v[48:55], v5
  s_waitcnt lgkmcnt(4)
  v_mfma_f32_32x32x16_bf16 v[64:79], v[56:59], v[104:107], v[64:79]
  ds_read_b64_tr_b16 v[52:53], v3 offset:10240
  ds_read_b64_tr_b16 v[54:55], v3 offset:10752
  ds_read_b64_tr_b16 v[48:49], v3 offset:8192
  ds_read_b64_tr_b16 v[50:51], v3 offset:8704
  v_mfma_f32_32x32x16_bf16 v[64:79], v[60:63], v[108:111], v[64:79]
  v_smfmac_f32_16x16x64_bf16 v[36:39], v[32:35], v[56:63], v5
  s_waitcnt lgkmcnt(4)
  v_mfma_f32_32x32x16_bf16 v[64:79], v[40:43], v[112:115], v[64:79]
  ds_read_b64_tr_b16 v[60:61], v2 offset:18432
  ds_read_b64_tr_b16 v[62:63], v2 offset:18944
  ds_read_b64_tr_b16 v[56:57], v2 offset:16384
  ds_read_b64_tr_b16 v[58:59], v2 offset:16896
  v_mfma_f32_32x32x16_bf16 v[64:79], v[44:47], v[116:119], v[64:79]
  v_mul_f32 v24, v80, v80
  v_mul_f32 v25, v81, v81
  v_mul_f32 v26, v82, v82
  v_mul_f32 v27, v83, v83
  v_fma_f32 v24, v24, v7, v6
  v_fma_f32 v25, v25, v7, v6
  v_fma_f32 v26, v26, v7, v6
  v_fma_f32 v27, v27, v7, v6
  v_mul_f32 v24, v24, v80
  v_mul_f32 v25, v25, v81
  v_mul_f32 v26, v26, v82
  v_smfmac_f32_16x16x64_bf16 v[36:39], v[32:35], v[40:47], v5
  v_mul_f32 v27, v27, v83
  v_exp_f32 v24, v24
  s_waitcnt lgkmcnt(4)
  v_mfma_f32_32x32x16_bf16 v[64:79], v[48:51], v[120:123], v[64:79]
  ds_read_b64_tr_b16 v[44:45], v3 offset:18432
  ds_read_b64_tr_b16 v[46:47], v3 offset:18944
  ds_read_b64_tr_b16 v[40:41], v3 offset:16384
  ds_read_b64_tr_b16 v[42:43], v3 offset:16896
  v_mfma_f32_32x32x16_bf16 v[64:79], v[52:55], v[124:127], v[64:79]
  s_waitcnt vmcnt(0)
  v_mov_b32 v9, 1
  s_mov_b64 exec, 3
  buffer_atomic_add v9, v15, s[48:51], s77 offen sc1
  s_mov_b64 exec, -1
  v_smfmac_f32_16x16x64_bf16 v[36:39], v[32:35], v[48:55], v5
  v_exp_f32 v25, v25
  s_waitcnt lgkmcnt(4)
  v_mfma_f32_32x32x16_bf16 v[64:79], v[56:59], v[128:131], v[64:79]
  ds_read_b32 v9, v8 offset:24
  ds_read_b64_tr_b16 v[52:53], v2 offset:26624
  ds_read_b64_tr_b16 v[54:55], v2 offset:27136
  ds_read_b64_tr_b16 v[48:49], v2 offset:24576
  ds_read_b64_tr_b16 v[50:51], v2 offset:25088
  v_mfma_f32_32x32x16_bf16 v[64:79], v[60:63], v[132:135], v[64:79]
  v_exp_f32 v26, v26
  v_exp_f32 v27, v27
  v_fma_f32 v24, v24, v10, v10
  v_fma_f32 v25, v25, v10, v10
  v_fma_f32 v26, v26, v10, v10
  v_fma_f32 v27, v27, v10, v10
  v_rcp_f32 v24, v24
  v_rcp_f32 v25, v25
  v_smfmac_f32_16x16x64_bf16 v[36:39], v[32:35], v[56:63], v5
  v_rcp_f32 v26, v26
  s_waitcnt lgkmcnt(5)
  v_mfma_f32_32x32x16_bf16 v[64:79], v[40:43], v[136:139], v[64:79]
  s_waitcnt lgkmcnt(4)
  v_cmp_ne_u32 vcc, 0, v9
  s_cbranch_vccnz SL_111
BK_112:
  ds_read_b64_tr_b16 v[60:61], v3 offset:26624
  ds_read_b64_tr_b16 v[62:63], v3 offset:27136
  ds_read_b64_tr_b16 v[56:57], v3 offset:24576
  ds_read_b64_tr_b16 v[58:59], v3 offset:25088
  v_mfma_f32_32x32x16_bf16 v[64:79], v[44:47], v[140:143], v[64:79]
  v_rcp_f32 v27, v27
  v_mul_f32 v24, v24, v80
  v_mul_f32 v25, v25, v81
  v_mul_f32 v26, v26, v82
  v_mul_f32 v27, v27, v83
  v_cvt_pk_bf16_f32 v28, v24, v25
  v_cvt_pk_bf16_f32 v29, v26, v27
  v_mul_f32 v24, v84, v84
  v_mul_f32 v25, v85, v85
  v_mul_f32 v26, v86, v86
  v_smfmac_f32_16x16x64_bf16 v[36:39], v[32:35], v[40:47], v5
  v_mul_f32 v27, v87, v87
  v_fma_f32 v24, v24, v7, v6
  v_fma_f32 v25, v25, v7, v6
  s_waitcnt lgkmcnt(4)
  v_mfma_f32_32x32x16_bf16 v[64:79], v[48:51], v[144:147], v[64:79]
  ds_read_b64_tr_b16 v[44:45], v2 offset:34816
  ds_read_b64_tr_b16 v[46:47], v2 offset:35328
  ds_read_b64_tr_b16 v[40:41], v2 offset:32768
  ds_read_b64_tr_b16 v[42:43], v2 offset:33280
  v_mfma_f32_32x32x16_bf16 v[64:79], v[52:55], v[148:151], v[64:79]
  v_fma_f32 v26, v26, v7, v6
  v_fma_f32 v27, v27, v7, v6
  v_mul_f32 v24, v24, v84
  v_mul_f32 v25, v25, v85
  v_mul_f32 v26, v26, v86
  v_mul_f32 v27, v27, v87
  v_exp_f32 v24, v24
  v_exp_f32 v25, v25
  v_smfmac_f32_16x16x64_bf16 v[36:39], v[32:35], v[48:55], v5
  v_exp_f32 v26, v26
  v_exp_f32 v27, v27
  s_waitcnt lgkmcnt(4)
  v_mfma_f32_32x32x16_bf16 v[64:79], v[56:59], v[152:155], v[64:79]
  ds_read_b64_tr_b16 v[52:53], v3 offset:34816
  ds_read_b64_tr_b16 v[54:55], v3 offset:35328
  ds_read_b64_tr_b16 v[48:49], v3 offset:32768
  ds_read_b64_tr_b16 v[50:51], v3 offset:33280
  v_mfma_f32_32x32x16_bf16 v[64:79], v[60:63], v[156:159], v[64:79]
  s_mov_b64 exec, s[78:79]
  ds_write_b32 v11, v1 offset:160
  s_mov_b64 exec, -1
  v_add_u32 v2, 40960, v2
  v_add_u32 v3, 40960, v3
  v_smfmac_f32_16x16x64_bf16 v[36:39], v[32:35], v[56:63], v5
  v_fma_f32 v24, v24, v10, v10
  v_fma_f32 v25, v25, v10, v10
  s_waitcnt lgkmcnt(5)
  v_mfma_f32_32x32x16_bf16 v[64:79], v[40:43], v[160:163], v[64:79]
  ds_read_b32 v9, v8 offset:348
  ds_read_b64_tr_b16 v[60:61], v2 offset:2048
  ds_read_b64_tr_b16 v[62:63], v2 offset:2560
  ds_read_b64_tr_b16 v[56:57], v2 offset:0
  ds_read_b64_tr_b16 v[58:59], v2 offset:512
  v_mfma_f32_32x32x16_bf16 v[64:79], v[44:47], v[164:167], v[64:79]
  v_fma_f32 v26, v26, v10, v10
  v_fma_f32 v27, v27, v10, v10
  v_rcp_f32 v24, v24
  v_rcp_f32 v25, v25
  v_rcp_f32 v26, v26
  v_rcp_f32 v27, v27
  v_mul_f32 v24, v24, v84
  v_smfmac_f32_16x16x64_bf16 v[36:39], v[32:35], v[40:47], v5
  v_mul_f32 v25, v25, v85
  v_mul_f32 v26, v26, v86
  v_mul_f32 v27, v27, v87
  s_waitcnt lgkmcnt(6)
  v_mfma_f32_32x32x16_bf16 v[64:79], v[48:51], v[168:171], v[64:79]
  s_waitcnt lgkmcnt(4)
  v_cmp_ne_u32 vcc, 0, v9
  s_cbranch_vccnz SL_115
BK_116:
  ds_read_b64_tr_b16 v[44:45], v3 offset:2048
  ds_read_b64_tr_b16 v[46:47], v3 offset:2560
  ds_read_b64_tr_b16 v[40:41], v3 offset:0
  ds_read_b64_tr_b16 v[42:43], v3 offset:512
  v_mfma_f32_32x32x16_bf16 v[64:79], v[52:55], v[172:175], v[64:79]
  v_cvt_pk_bf16_f32 v30, v24, v25
  v_cvt_pk_bf16_f32 v31, v26, v27
  buffer_store_dwordx4 v[28:31], v4, s[48:51], s56 offen offset:0 sc1
  v_mul_f32 v24, v88, v88
  v_mul_f32 v25, v89, v89
  v_mul_f32 v26, v90, v90
  v_mul_f32 v27, v91, v91
  v_fma_f32 v24, v24, v7, v6
  v_fma_f32 v25, v25, v7, v6
  v_fma_f32 v26, v26, v7, v6
  v_smfmac_f32_16x16x64_bf16 v[36:39], v[32:35], v[48:55], v5
  v_fma_f32 v27, v27, v7, v6
  v_mul_f32 v24, v24, v88
  s_waitcnt lgkmcnt(4)
  v_mfma_f32_32x32x16_bf16 v[64:79], v[56:59], v[176:179], v[64:79]
  ds_read_b64_tr_b16 v[52:53], v2 offset:10240
  ds_read_b64_tr_b16 v[54:55], v2 offset:10752
  ds_read_b64_tr_b16 v[48:49], v2 offset:8192
  ds_read_b64_tr_b16 v[50:51], v2 offset:8704
  v_mfma_f32_32x32x16_bf16 v[64:79], v[60:63], v[180:183], v[64:79]
  v_mul_f32 v25, v25, v89
  v_mul_f32 v26, v26, v90
  v_mul_f32 v27, v27, v91
  v_exp_f32 v24, v24
  v_exp_f32 v25, v25
  v_exp_f32 v26, v26
  v_exp_f32 v27, v27
  v_fma_f32 v24, v24, v10, v10
  v_smfmac_f32_16x16x64_bf16 v[36:39], v[32:35], v[56:63], v5
  v_fma_f32 v25, v25, v10, v10
  v_fma_f32 v26, v26, v10, v10
  s_waitcnt lgkmcnt(4)
  v_mfma_f32_32x32x16_bf16 v[64:79], v[40:43], v[184:187], v[64:79]
  ds_read_b64_tr_b16 v[60:61], v3 offset:10240
  ds_read_b64_tr_b16 v[62:63], v3 offset:10752
  ds_read_b64_tr_b16 v[56:57], v3 offset:8192
  ds_read_b64_tr_b16 v[58:59], v3 offset:8704
  v_mfma_f32_32x32x16_bf16 v[64:79], v[44:47], v[188:191], v[64:79]
  v_fma_f32 v27, v27, v10, v10
  v_rcp_f32 v24, v24
  v_rcp_f32 v25, v25
  v_rcp_f32 v26, v26
  v_rcp_f32 v27, v27
  v_mul_f32 v24, v24, v88
  v_mul_f32 v25, v25, v89
  v_smfmac_f32_16x16x64_bf16 v[36:39], v[32:35], v[40:47], v5
  v_mul_f32 v26, v26, v90
  v_mul_f32 v27, v27, v91
  v_cvt_pk_bf16_f32 v28, v24, v25
  s_waitcnt lgkmcnt(4)
  v_mfma_f32_32x32x16_bf16 v[64:79], v[48:51], v[192:195], v[64:79]
  ds_read_b64_tr_b16 v[44:45], v2 offset:18432
  ds_read_b64_tr_b16 v[46:47], v2 offset:18944
  ds_read_b64_tr_b16 v[40:41], v2 offset:16384
  ds_read_b64_tr_b16 v[42:43], v2 offset:16896
  v_mfma_f32_32x32x16_bf16 v[64:79], v[52:55], v[196:199], v[64:79]
  v_cvt_pk_bf16_f32 v29, v26, v27
  v_mul_f32 v24, v92, v92
  v_mul_f32 v25, v93, v93
  v_mul_f32 v26, v94, v94
  v_mul_f32 v27, v95, v95
  v_fma_f32 v24, v24, v7, v6
  v_fma_f32 v25, v25, v7, v6
  v_fma_f32 v26, v26, v7, v6
  v_fma_f32 v27, v27, v7, v6
  v_mul_f32 v24, v24, v92
  v_smfmac_f32_16x16x64_bf16 v[36:39], v[32:35], v[48:55], v5
  v_mul_f32 v25, v25, v93
  v_mul_f32 v26, v26, v94
  v_mul_f32 v27, v27, v95
  s_waitcnt lgkmcnt(4)
  v_mfma_f32_32x32x16_bf16 v[64:79], v[56:59], v[200:203], v[64:79]
  ds_read_b64_tr_b16 v[52:53], v3 offset:18432
  ds_read_b64_tr_b16 v[54:55], v3 offset:18944
  ds_read_b64_tr_b16 v[48:49], v3 offset:16384
  ds_read_b64_tr_b16 v[50:51], v3 offset:16896
  v_mfma_f32_32x32x16_bf16 v[64:79], v[60:63], v[204:207], v[64:79]
  v_exp_f32 v24, v24
  v_exp_f32 v25, v25
  v_exp_f32 v26, v26
  v_exp_f32 v27, v27
  v_fma_f32 v24, v24, v10, v10
  v_fma_f32 v25, v25, v10, v10
  v_fma_f32 v26, v26, v10, v10
  v_smfmac_f32_16x16x64_bf16 v[36:39], v[32:35], v[56:63], v5
  v_fma_f32 v27, v27, v10, v10
  v_rcp_f32 v24, v24
  s_waitcnt lgkmcnt(4)
  v_mfma_f32_32x32x16_bf16 v[64:79], v[40:43], v[208:211], v[64:79]
  ds_read_b32 v9, v8 offset:28
  ds_read_b64_tr_b16 v[60:61], v2 offset:26624
  ds_read_b64_tr_b16 v[62:63], v2 offset:27136
  ds_read_b64_tr_b16 v[56:57], v2 offset:24576
  ds_read_b64_tr_b16 v[58:59], v2 offset:25088
  v_mfma_f32_32x32x16_bf16 v[64:79], v[44:47], v[212:215], v[64:79]
  v_rcp_f32 v25, v25
  v_rcp_f32 v26, v26
  v_rcp_f32 v27, v27
  v_mul_f32 v24, v24, v92
  v_mul_f32 v25, v25, v93
  v_mul_f32 v26, v26, v94
  v_mul_f32 v27, v27, v95
  v_cvt_pk_bf16_f32 v30, v24, v25
  v_smfmac_f32_16x16x64_bf16 v[36:39], v[32:35], v[40:47], v5
  v_cvt_pk_bf16_f32 v31, v26, v27
  buffer_store_dwordx4 v[28:31], v4, s[48:51], s56 offen offset:512 sc1
  s_waitcnt lgkmcnt(5)
  v_mfma_f32_32x32x16_bf16 v[64:79], v[48:51], v[216:219], v[64:79]
  s_waitcnt lgkmcnt(4)
  v_cmp_ne_u32 vcc, 0, v9
  s_cbranch_vccnz SL_119
BK_120:
  ds_read_b64_tr_b16 v[44:45], v3 offset:26624
  ds_read_b64_tr_b16 v[46:47], v3 offset:27136
  ds_read_b64_tr_b16 v[40:41], v3 offset:24576
  ds_read_b64_tr_b16 v[42:43], v3 offset:25088
  v_mfma_f32_32x32x16_bf16 v[64:79], v[52:55], v[220:223], v[64:79]
  v_smfmac_f32_16x16x64_bf16 v[36:39], v[32:35], v[48:55], v5
  s_waitcnt lgkmcnt(4)
  v_mfma_f32_32x32x16_bf16 v[64:79], v[56:59], v[224:227], v[64:79]
  ds_read_b64_tr_b16 v[52:53], v2 offset:34816
  ds_read_b64_tr_b16 v[54:55], v2 offset:35328
  ds_read_b64_tr_b16 v[48:49], v2 offset:32768
  ds_read_b64_tr_b16 v[50:51], v2 offset:33280
  v_mfma_f32_32x32x16_bf16 v[64:79], v[60:63], v[228:231], v[64:79]
  v_smfmac_f32_16x16x64_bf16 v[36:39], v[32:35], v[56:63], v5
  s_waitcnt lgkmcnt(4)
  v_mfma_f32_32x32x16_bf16 v[64:79], v[40:43], v[232:235], v[64:79]
  ds_read_b64_tr_b16 v[60:61], v3 offset:34816
  ds_read_b64_tr_b16 v[62:63], v3 offset:35328
  ds_read_b64_tr_b16 v[56:57], v3 offset:32768
  ds_read_b64_tr_b16 v[58:59], v3 offset:33280
  v_mfma_f32_32x32x16_bf16 v[64:79], v[44:47], v[236:239], v[64:79]
  s_mov_b64 exec, s[78:79]
  ds_write_b32 v11, v1 offset:176
  s_mov_b64 exec, -1
  v_smfmac_f32_16x16x64_bf16 v[36:39], v[32:35], v[40:47], v5
  s_waitcnt lgkmcnt(5)
  v_mfma_f32_32x32x16_bf16 v[64:79], v[48:51], v[240:243], v[64:79]
  v_mfma_f32_32x32x16_bf16 v[64:79], v[52:55], v[244:247], v[64:79]
  v_smfmac_f32_16x16x64_bf16 v[36:39], v[32:35], v[48:55], v5
  s_waitcnt lgkmcnt(1)
  v_smfmac_f32_16x16x64_bf16 v[36:39], v[32:35], v[56:63], v5
  v_mfma_f32_32x32x16_bf16 v[64:79], v[56:59], v[248:251], v[64:79]
  v_mfma_f32_32x32x16_bf16 v[64:79], v[60:63], v[252:255], v[64:79]
  s_lshr_b32 s63, s5, 2
  s_lshl_b32 s63, s63, 7
  s_add_u32 s69, s77, s63
  s_lshl_b32 s67, s4, 2
  s_add_u32 s67, s67, s3
  s_mul_i32 s68, s67, 49152
  v_lshlrev_b32 v3, 4, v0
  s_lshl_b32 s64, s52, 14
  s_add_u32 s64, s64, s68
  s_lshl_b32 s65, s53, 14
  s_add_u32 s65, s65, s68
  s_lshl_b32 s66, s54, 14
  s_add_u32 s66, s66, s68
  s_and_b32 s72, s5, 1
  s_lshl_b32 s72, s72, 13
  s_add_u32 s73, s72, 4096
  s_xor_b32 s74, s72, 8192
  s_xor_b32 s75, s73, 8192
  v_cvt_pk_bf16_f32 v22, v14, 0
  v_add_f32 v24, v36, v37
  v_mov_b32 v36, 0
  v_mov_b32 v37, 0
  v_cvt_pk_bf16_f32 v20, v24, v24
  v_and_b32 v25, 0xffff0000, v20
  v_sub_f32 v24, v24, v25
  v_cvt_pk_bf16_f32 v21, v24, v14
  s_nop 1
  v_mfma_f32_32x32x16_bf16 v[64:79], v[20:23], v[16:19], v[64:79]
  v_mov_b32 v5, 0
  s_mov_b64 exec, 1
  buffer_atomic_add v5, off, s[48:51], s69 sc0 sc1
  s_mov_b64 exec, -1
  s_nop 7
  v_mul_f32 v24, v64, v64
  v_mul_f32 v25, v65, v65
  v_mul_f32 v26, v66, v66
  v_mul_f32 v27, v67, v67
  v_fma_f32 v24, v24, v7, v6
  v_fma_f32 v25, v25, v7, v6
  v_fma_f32 v26, v26, v7, v6
  v_fma_f32 v27, v27, v7, v6
  v_mul_f32 v24, v24, v64
  v_mul_f32 v25, v25, v65
  v_mul_f32 v26, v26, v66
  v_mul_f32 v27, v27, v67
  v_exp_f32 v24, v24
  v_exp_f32 v25, v25
  v_exp_f32 v26, v26
  v_exp_f32 v27, v27
  v_fma_f32 v24, v24, v10, v10
  v_fma_f32 v25, v25, v10, v10
  v_fma_f32 v26, v26, v10, v10
  v_fma_f32 v27, v27, v10, v10
  v_rcp_f32 v24, v24
  v_rcp_f32 v25, v25
  v_rcp_f32 v26, v26
  v_rcp_f32 v27, v27
  v_mul_f32 v24, v24, v64
  v_mul_f32 v25, v25, v65
  v_mul_f32 v26, v26, v66
  v_mul_f32 v27, v27, v67
  v_cvt_pk_bf16_f32 v28, v24, v25
  v_cvt_pk_bf16_f32 v29, v26, v27
  v_mul_f32 v24, v68, v68
  v_mul_f32 v25, v69, v69
  v_mul_f32 v26, v70, v70
  v_mul_f32 v27, v71, v71
  v_fma_f32 v24, v24, v7, v6
  v_fma_f32 v25, v25, v7, v6
  v_fma_f32 v26, v26, v7, v6
  v_fma_f32 v27, v27, v7, v6
  v_mul_f32 v24, v24, v68
  v_mul_f32 v25, v25, v69
  v_mul_f32 v26, v26, v70
  v_mul_f32 v27, v27, v71
  v_exp_f32 v24, v24
  v_exp_f32 v25, v25
  v_exp_f32 v26, v26
  v_exp_f32 v27, v27
  v_fma_f32 v24, v24, v10, v10
  v_fma_f32 v25, v25, v10, v10
  v_fma_f32 v26, v26, v10, v10
  v_fma_f32 v27, v27, v10, v10
  v_rcp_f32 v24, v24
  v_rcp_f32 v25, v25
  v_rcp_f32 v26, v26
  v_rcp_f32 v27, v27
  v_mul_f32 v24, v24, v68
  v_mul_f32 v25, v25, v69
  v_mul_f32 v26, v26, v70
  v_mul_f32 v27, v27, v71
  v_cvt_pk_bf16_f32 v30, v24, v25
  v_cvt_pk_bf16_f32 v31, v26, v27
  buffer_store_dwordx4 v[28:31], v4, s[48:51], s57 offen offset:0 sc1
  v_mul_f32 v24, v72, v72
  v_mul_f32 v25, v73, v73
  v_mul_f32 v26, v74, v74
  v_mul_f32 v27, v75, v75
  v_fma_f32 v24, v24, v7, v6
  v_fma_f32 v25, v25, v7, v6
  v_fma_f32 v26, v26, v7, v6
  v_fma_f32 v27, v27, v7, v6
  v_mul_f32 v24, v24, v72
  v_mul_f32 v25, v25, v73
  v_mul_f32 v26, v26, v74
  v_mul_f32 v27, v27, v75
  v_exp_f32 v24, v24
  v_exp_f32 v25, v25
  v_exp_f32 v26, v26
  v_exp_f32 v27, v27
  v_fma_f32 v24, v24, v10, v10
  v_fma_f32 v25, v25, v10, v10
  v_fma_f32 v26, v26, v10, v10
  v_fma_f32 v27, v27, v10, v10
  v_rcp_f32 v24, v24
  v_rcp_f32 v25, v25
  v_rcp_f32 v26, v26
  v_rcp_f32 v27, v27
  v_mul_f32 v24, v24, v72
  v_mul_f32 v25, v25, v73
  v_mul_f32 v26, v26, v74
  v_mul_f32 v27, v27, v75
  v_cvt_pk_bf16_f32 v28, v24, v25
  v_cvt_pk_bf16_f32 v29, v26, v27
  v_mul_f32 v24, v76, v76
  v_mul_f32 v25, v77, v77
  v_mul_f32 v26, v78, v78
  v_mul_f32 v27, v79, v79
  v_fma_f32 v24, v24, v7, v6
  v_fma_f32 v25, v25, v7, v6
  v_fma_f32 v26, v26, v7, v6
  v_fma_f32 v27, v27, v7, v6
  v_mul_f32 v24, v24, v76
  v_mul_f32 v25, v25, v77
  v_mul_f32 v26, v26, v78
  v_mul_f32 v27, v27, v79
  v_exp_f32 v24, v24
  v_exp_f32 v25, v25
  v_exp_f32 v26, v26
  v_exp_f32 v27, v27
  v_fma_f32 v24, v24, v10, v10
  v_fma_f32 v25, v25, v10, v10
  v_fma_f32 v26, v26, v10, v10
  v_fma_f32 v27, v27, v10, v10
  v_rcp_f32 v24, v24
  v_rcp_f32 v25, v25
  v_rcp_f32 v26, v26
  v_rcp_f32 v27, v27
  v_mul_f32 v24, v24, v76
  v_mul_f32 v25, v25, v77
  v_mul_f32 v26, v26, v78
  v_mul_f32 v27, v27, v79
  v_cvt_pk_bf16_f32 v30, v24, v25
  v_cvt_pk_bf16_f32 v31, v26, v27
  buffer_store_dwordx4 v[28:31], v4, s[48:51], s57 offen offset:512 sc1
  s_waitcnt vmcnt(3)
  v_mov_b32 v9, 256
  s_mov_b64 exec, 3
  buffer_atomic_add v9, v15, s[48:51], s77 offen sc1
  s_mov_b64 exec, -1
  v_add_u32 v2, 122880, v3
  v_mov_b32 v4, v15
  s_mov_b32 s61, 0x10000
  s_waitcnt vmcnt(3)
  v_readfirstlane_b32 s63, v5
  s_bitcmp1_b32 s63, 4
  s_cbranch_scc0 SL_123
BK_124:
  s_add_u32 s62, s64, s72
  buffer_load_dwordx4 v[96:99], v3, s[48:51], s62 offen offset:0 sc1
  buffer_load_dwordx4 v[100:103], v3, s[48:51], s62 offen offset:1024 sc1
  buffer_load_dwordx4 v[104:107], v3, s[48:51], s62 offen offset:2048 sc1
  buffer_load_dwordx4 v[108:111], v3, s[48:51], s62 offen offset:3072 sc1
  s_waitcnt vmcnt(5)
  v_mov_b32 v9, s61
  s_mov_b64 exec, 3
  buffer_atomic_add v9, v4, s[48:51], s77 offen sc1
  s_mov_b64 exec, -1
  s_add_u32 s62, s64, s73
  buffer_load_dwordx4 v[112:115], v3, s[48:51], s62 offen offset:0 sc1
  buffer_load_dwordx4 v[116:119], v3, s[48:51], s62 offen offset:1024 sc1
  buffer_load_dwordx4 v[120:123], v3, s[48:51], s62 offen offset:2048 sc1
  buffer_load_dwordx4 v[124:127], v3, s[48:51], s62 offen offset:3072 sc1
  s_add_u32 s62, s64, s74
  buffer_load_dwordx4 v[128:131], v3, s[48:51], s62 offen offset:0 sc1
  buffer_load_dwordx4 v[132:135], v3, s[48:51], s62 offen offset:1024 sc1
  buffer_load_dwordx4 v[136:139], v3, s[48:51], s62 offen offset:2048 sc1
  buffer_load_dwordx4 v[140:143], v3, s[48:51], s62 offen offset:3072 sc1
  s_add_u32 s62, s64, s75
  buffer_load_dwordx4 v[144:147], v3, s[48:51], s62 offen offset:0 sc1
  buffer_load_dwordx4 v[148:151], v3, s[48:51], s62 offen offset:1024 sc1
  buffer_load_dwordx4 v[152:155], v3, s[48:51], s62 offen offset:2048 sc1
  buffer_load_dwordx4 v[156:159], v3, s[48:51], s62 offen offset:3072 sc1
  v_mov_b32 v5, 0
  s_mov_b64 exec, 1
  buffer_atomic_add v5, off, s[48:51], s69 sc0 sc1
  s_mov_b64 exec, -1
SP_132:
  ds_read_b32 v9, v8 offset:352
  s_waitcnt lgkmcnt(0)
  v_cmp_ne_u32 vcc, 0, v9
  s_cbranch_vccz SO_133
  s_sleep 2
  s_sub_u32 s12, s12, 1
  s_cbranch_scc0 SP_132
  s_mov_b32 s12, 0
SO_133:
  ds_read_b128 v[32:35], v2 offset:0
  ds_read_b128 v[36:39], v2 offset:1024
  ds_read_b128 v[40:43], v2 offset:2048
  ds_read_b128 v[44:47], v2 offset:3072
  ds_read_b128 v[48:51], v2 offset:4096
  ds_read_b128 v[52:55], v2 offset:5120
  ds_read_b128 v[56:59], v2 offset:6144
  ds_read_b128 v[60:63], v2 offset:7168
  ds_read_b128 v[64:67], v2 offset:8192
  ds_read_b128 v[68:71], v2 offset:9216
  s_waitcnt lgkmcnt(7)
  s_waitcnt vmcnt(17)
  v_mfma_f32_16x16x32_bf16 v[12:15], v[32:35], v[96:99], 0
  ds_read_b128 v[32:35], v2 offset:10240
  v_mfma_f32_16x16x32_bf16 v[16:19], v[36:39], v[96:99], 0
  ds_read_b128 v[36:39], v2 offset:11264
  v_mfma_f32_16x16x32_bf16 v[20:23], v[40:43], v[96:99], 0
  ds_read_b128 v[40:43], v2 offset:12288
  s_waitcnt lgkmcnt(8)
  v_mfma_f32_16x16x32_bf16 v[24:27], v[44:47], v[96:99], 0
  ds_read_b128 v[44:47], v2 offset:13312
  v_mfma_f32_16x16x32_bf16 v[28:31], v[48:51], v[96:99], 0
  ds_read_b128 v[48:51], v2 offset:14336
  s_waitcnt lgkmcnt(5)
  s_waitcnt vmcnt(16)
  v_mfma_f32_16x16x32_bf16 v[28:31], v[68:71], v[100:103], v[28:31]
  ds_read_b128 v[68:71], v2 offset:19456
  v_mfma_f32_16x16x32_bf16 v[24:27], v[64:67], v[100:103], v[24:27]
  ds_read_b128 v[64:67], v2 offset:18432
  v_mfma_f32_16x16x32_bf16 v[20:23], v[60:63], v[100:103], v[20:23]
  ds_read_b128 v[60:63], v2 offset:17408
  v_mfma_f32_16x16x32_bf16 v[16:19], v[56:59], v[100:103], v[16:19]
  ds_read_b128 v[56:59], v2 offset:16384
  v_mfma_f32_16x16x32_bf16 v[12:15], v[52:55], v[100:103], v[12:15]
  ds_read_b128 v[52:55], v2 offset:15360
  ds_read_b32 v9, v8 offset:32
  s_waitcnt lgkmcnt(8)
  s_waitcnt vmcnt(15)
  v_mfma_f32_16x16x32_bf16 v[12:15], v[32:35], v[104:107], v[12:15]
  ds_read_b128 v[32:35], v2 offset:20480
  v_mfma_f32_16x16x32_bf16 v[16:19], v[36:39], v[104:107], v[16:19]
  ds_read_b128 v[36:39], v2 offset:21504
  v_mfma_f32_16x16x32_bf16 v[20:23], v[40:43], v[104:107], v[20:23]
  ds_read_b128 v[40:43], v2 offset:22528
  s_waitcnt lgkmcnt(9)
  v_mfma_f32_16x16x32_bf16 v[24:27], v[44:47], v[104:107], v[24:27]
  ds_read_b128 v[44:47], v2 offset:23552
  v_mfma_f32_16x16x32_bf16 v[28:31], v[48:51], v[104:107], v[28:31]
  ds_read_b128 v[48:51], v2 offset:24576
  s_waitcnt lgkmcnt(5)
  v_cmp_ne_u32 vcc, 0, v9
  s_cbranch_vccnz SL_134
BK_135:
  s_waitcnt vmcnt(14)
  v_mfma_f32_16x16x32_bf16 v[28:31], v[68:71], v[108:111], v[28:31]
  ds_read_b128 v[68:71], v2 offset:29696
  v_mfma_f32_16x16x32_bf16 v[24:27], v[64:67], v[108:111], v[24:27]
  ds_read_b128 v[64:67], v2 offset:28672
  v_mfma_f32_16x16x32_bf16 v[20:23], v[60:63], v[108:111], v[20:23]
  ds_read_b128 v[60:63], v2 offset:27648
  v_mfma_f32_16x16x32_bf16 v[16:19], v[56:59], v[108:111], v[16:19]
  ds_read_b128 v[56:59], v2 offset:26624
  v_mfma_f32_16x16x32_bf16 v[12:15], v[52:55], v[108:111], v[12:15]
  ds_read_b128 v[52:55], v2 offset:25600
  s_waitcnt vmcnt(0)
  v_readfirstlane_b32 s63, v5
  s_bitcmp1_b32 s63, 12
  s_cbranch_scc0 SL_126
BK_127:
  s_waitcnt lgkmcnt(7)
  v_mfma_f32_16x16x32_bf16 v[12:15], v[32:35], v[112:115], v[12:15]
  ds_read_b128 v[32:35], v2 offset:30720
  s_add_u32 s62, s65, s72
  buffer_load_dwordx4 v[160:163], v3, s[48:51], s62 offen offset:0 sc1
  buffer_load_dwordx4 v[164:167], v3, s[48:51], s62 offen offset:1024 sc1
  buffer_load_dwordx4 v[168:171], v3, s[48:51], s62 offen offset:2048 sc1
  v_mfma_f32_16x16x32_bf16 v[16:19], v[36:39], v[112:115], v[16:19]
  ds_read_b128 v[36:39], v2 offset:31744
  buffer_load_dwordx4 v[172:175], v3, s[48:51], s62 offen offset:3072 sc1
  s_add_u32 s62, s65, s73
  buffer_load_dwordx4 v[176:179], v3, s[48:51], s62 offen offset:0 sc1
  buffer_load_dwordx4 v[180:183], v3, s[48:51], s62 offen offset:1024 sc1
  v_mfma_f32_16x16x32_bf16 v[20:23], v[40:43], v[112:115], v[20:23]
  ds_read_b128 v[40:43], v2 offset:32768
  buffer_load_dwordx4 v[184:187], v3, s[48:51], s62 offen offset:2048 sc1
  buffer_load_dwordx4 v[188:191], v3, s[48:51], s62 offen offset:3072 sc1
  s_add_u32 s62, s65, s74
  buffer_load_dwordx4 v[192:195], v3, s[48:51], s62 offen offset:0 sc1
  s_waitcnt lgkmcnt(8)
  v_mfma_f32_16x16x32_bf16 v[24:27], v[44:47], v[112:115], v[24:27]
  ds_read_b128 v[44:47], v2 offset:33792
  buffer_load_dwordx4 v[196:199], v3, s[48:51], s62 offen offset:1024 sc1
  buffer_load_dwordx4 v[200:203], v3, s[48:51], s62 offen offset:2048 sc1
  buffer_load_dwordx4 v[204:207], v3, s[48:51], s62 offen offset:3072 sc1
  v_mfma_f32_16x16x32_bf16 v[28:31], v[48:51], v[112:115], v[28:31]
  ds_read_b128 v[48:51], v2 offset:34816
  s_add_u32 s62, s65, s75
  buffer_load_dwordx4 v[208:211], v3, s[48:51], s62 offen offset:0 sc1
  buffer_load_dwordx4 v[212:215], v3, s[48:51], s62 offen offset:1024 sc1
  buffer_load_dwordx4 v[216:219], v3, s[48:51], s62 offen offset:2048 sc1
  buffer_load_dwordx4 v[220:223], v3, s[48:51], s62 offen offset:3072 sc1
  s_waitcnt lgkmcnt(7)
  v_mfma_f32_16x16x32_bf16 v[28:31], v[68:71], v[116:119], v[28:31]
  ds_read_b128 v[68:71], v2 offset:39936
  v_mfma_f32_16x16x32_bf16 v[24:27], v[64:67], v[116:119], v[24:27]
  ds_read_b128 v[64:67], v2 offset:38912
  v_mfma_f32_16x16x32_bf16 v[20:23], v[60:63], v[116:119], v[20:23]
  ds_read_b128 v[60:63], v2 offset:37888
  s_waitcnt lgkmcnt(8)
  v_mfma_f32_16x16x32_bf16 v[16:19], v[56:59], v[116:119], v[16:19]
  ds_read_b128 v[56:59], v2 offset:36864
  v_mfma_f32_16x16x32_bf16 v[12:15], v[52:55], v[116:119], v[12:15]
  ds_read_b128 v[52:55], v2 offset:35840
  s_mov_b64 exec, s[78:79]
  ds_write_b32 v11, v1 offset:192
  s_mov_b64 exec, -1
  v_subrev_u32 v2, 81920, v2
  ds_read_b32 v9, v8 offset:356
  s_waitcnt lgkmcnt(9)
  v_mfma_f32_16x16x32_bf16 v[12:15], v[32:35], v[120:123], v[12:15]
  ds_read_b128 v[32:35], v2 offset:0
  v_mfma_f32_16x16x32_bf16 v[16:19], v[36:39], v[120:123], v[16:19]
  ds_read_b128 v[36:39], v2 offset:1024
  v_mfma_f32_16x16x32_bf16 v[20:23], v[40:43], v[120:123], v[20:23]
  ds_read_b128 v[40:43], v2 offset:2048
  s_waitcnt lgkmcnt(10)
  v_mfma_f32_16x16x32_bf16 v[24:27], v[44:47], v[120:123], v[24:27]
  ds_read_b128 v[44:47], v2 offset:3072
  v_mfma_f32_16x16x32_bf16 v[28:31], v[48:51], v[120:123], v[28:31]
  ds_read_b128 v[48:51], v2 offset:4096
  s_waitcnt lgkmcnt(5)
  v_cmp_ne_u32 vcc, 0, v9
  s_cbranch_vccnz SL_138
BK_139:
  s_setprio 0
  v_mfma_f32_16x16x32_bf16 v[28:31], v[68:71], v[124:127], v[28:31]
  ds_read_b128 v[68:71], v2 offset:9216
  v_mfma_f32_16x16x32_bf16 v[24:27], v[64:67], v[124:127], v[24:27]
  ds_read_b128 v[64:67], v2 offset:8192
  v_mfma_f32_16x16x32_bf16 v[20:23], v[60:63], v[124:127], v[20:23]
  ds_read_b128 v[60:63], v2 offset:7168
  v_mfma_f32_16x16x32_bf16 v[16:19], v[56:59], v[124:127], v[16:19]
  ds_read_b128 v[56:59], v2 offset:6144
  v_mfma_f32_16x16x32_bf16 v[12:15], v[52:55], v[124:127], v[12:15]
  ds_read_b128 v[52:55], v2 offset:5120
  s_waitcnt lgkmcnt(7)
  v_mfma_f32_16x16x32_bf16 v[12:15], v[32:35], v[128:131], v[12:15]
  ds_read_b128 v[32:35], v2 offset:10240
  v_mfma_f32_16x16x32_bf16 v[16:19], v[36:39], v[128:131], v[16:19]
  ds_read_b128 v[36:39], v2 offset:11264
  v_mfma_f32_16x16x32_bf16 v[20:23], v[40:43], v[128:131], v[20:23]
  ds_read_b128 v[40:43], v2 offset:12288
  s_waitcnt lgkmcnt(8)
  v_mfma_f32_16x16x32_bf16 v[24:27], v[44:47], v[128:131], v[24:27]
  ds_read_b128 v[44:47], v2 offset:13312
  v_mfma_f32_16x16x32_bf16 v[28:31], v[48:51], v[128:131], v[28:31]
  ds_read_b128 v[48:51], v2 offset:14336
  s_waitcnt lgkmcnt(7)
  v_mfma_f32_16x16x32_bf16 v[28:31], v[68:71], v[132:135], v[28:31]
  ds_read_b128 v[68:71], v2 offset:19456
  v_mfma_f32_16x16x32_bf16 v[24:27], v[64:67], v[132:135], v[24:27]
  ds_read_b128 v[64:67], v2 offset:18432
  v_mfma_f32_16x16x32_bf16 v[20:23], v[60:63], v[132:135], v[20:23]
  ds_read_b128 v[60:63], v2 offset:17408
  s_waitcnt lgkmcnt(8)
  v_mfma_f32_16x16x32_bf16 v[16:19], v[56:59], v[132:135], v[16:19]
  ds_read_b128 v[56:59], v2 offset:16384
  v_mfma_f32_16x16x32_bf16 v[12:15], v[52:55], v[132:135], v[12:15]
  ds_read_b128 v[52:55], v2 offset:15360
  v_mov_b32 v5, 0
  s_mov_b64 exec, 1
  buffer_atomic_add v5, off, s[48:51], s69 sc0 sc1
  s_mov_b64 exec, -1
  ds_read_b32 v9, v8 offset:36
  s_waitcnt lgkmcnt(8)
  v_mfma_f32_16x16x32_bf16 v[12:15], v[32:35], v[136:139], v[12:15]
  ds_read_b128 v[32:35], v2 offset:20480
  v_mfma_f32_16x16x32_bf16 v[16:19], v[36:39], v[136:139], v[16:19]
  ds_read_b128 v[36:39], v2 offset:21504
  v_mfma_f32_16x16x32_bf16 v[20:23], v[40:43], v[136:139], v[20:23]
  ds_read_b128 v[40:43], v2 offset:22528
  s_waitcnt lgkmcnt(9)
  v_mfma_f32_16x16x32_bf16 v[24:27], v[44:47], v[136:139], v[24:27]
  ds_read_b128 v[44:47], v2 offset:23552
  v_mfma_f32_16x16x32_bf16 v[28:31], v[48:51], v[136:139], v[28:31]
  ds_read_b128 v[48:51], v2 offset:24576
  s_waitcnt lgkmcnt(5)
  v_cmp_ne_u32 vcc, 0, v9
  s_cbranch_vccnz SL_142
BK_143:
  v_mfma_f32_16x16x32_bf16 v[28:31], v[68:71], v[140:143], v[28:31]
  ds_read_b128 v[68:71], v2 offset:29696
  v_mfma_f32_16x16x32_bf16 v[24:27], v[64:67], v[140:143], v[24:27]
  ds_read_b128 v[64:67], v2 offset:28672
  v_mfma_f32_16x16x32_bf16 v[20:23], v[60:63], v[140:143], v[20:23]
  ds_read_b128 v[60:63], v2 offset:27648
  v_mfma_f32_16x16x32_bf16 v[16:19], v[56:59], v[140:143], v[16:19]
  ds_read_b128 v[56:59], v2 offset:26624
  v_mfma_f32_16x16x32_bf16 v[12:15], v[52:55], v[140:143], v[12:15]
  ds_read_b128 v[52:55], v2 offset:25600
  s_waitcnt lgkmcnt(7)
  v_mfma_f32_16x16x32_bf16 v[12:15], v[32:35], v[144:147], v[12:15]
  ds_read_b128 v[32:35], v2 offset:30720
  v_mfma_f32_16x16x32_bf16 v[16:19], v[36:39], v[144:147], v[16:19]
  ds_read_b128 v[36:39], v2 offset:31744
  v_mfma_f32_16x16x32_bf16 v[20:23], v[40:43], v[144:147], v[20:23]
  ds_read_b128 v[40:43], v2 offset:32768
  s_waitcnt lgkmcnt(8)
  v_mfma_f32_16x16x32_bf16 v[24:27], v[44:47], v[144:147], v[24:27]
  ds_read_b128 v[44:47], v2 offset:33792
  v_mfma_f32_16x16x32_bf16 v[28:31], v[48:51], v[144:147], v[28:31]
  ds_read_b128 v[48:51], v2 offset:34816
  s_waitcnt lgkmcnt(7)
  v_mfma_f32_16x16x32_bf16 v[28:31], v[68:71], v[148:151], v[28:31]
  ds_read_b128 v[68:71], v2 offset:39936
  v_mfma_f32_16x16x32_bf16 v[24:27], v[64:67], v[148:151], v[24:27]
  ds_read_b128 v[64:67], v2 offset:38912
  v_mfma_f32_16x16x32_bf16 v[20:23], v[60:63], v[148:151], v[20:23]
  ds_read_b128 v[60:63], v2 offset:37888
  s_waitcnt lgkmcnt(8)
  v_mfma_f32_16x16x32_bf16 v[16:19], v[56:59], v[148:151], v[16:19]
  ds_read_b128 v[56:59], v2 offset:36864
  v_mfma_f32_16x16x32_bf16 v[12:15], v[52:55], v[148:151], v[12:15]
  ds_read_b128 v[52:55], v2 offset:35840
  s_mov_b64 exec, s[78:79]
  ds_write_b32 v11, v1 offset:208
  s_mov_b64 exec, -1
  v_add_u32 v2, 40960, v2
  ds_read_b32 v9, v8 offset:360
  s_waitcnt lgkmcnt(9)
  v_mfma_f32_16x16x32_bf16 v[12:15], v[32:35], v[152:155], v[12:15]
  ds_read_b128 v[32:35], v2 offset:0
  v_mfma_f32_16x16x32_bf16 v[16:19], v[36:39], v[152:155], v[16:19]
  ds_read_b128 v[36:39], v2 offset:1024
  v_mfma_f32_16x16x32_bf16 v[20:23], v[40:43], v[152:155], v[20:23]
  ds_read_b128 v[40:43], v2 offset:2048
  s_waitcnt lgkmcnt(10)
  v_mfma_f32_16x16x32_bf16 v[24:27], v[44:47], v[152:155], v[24:27]
  ds_read_b128 v[44:47], v2 offset:3072
  v_mfma_f32_16x16x32_bf16 v[28:31], v[48:51], v[152:155], v[28:31]
  ds_read_b128 v[48:51], v2 offset:4096
  s_waitcnt lgkmcnt(5)
  v_cmp_ne_u32 vcc, 0, v9
  s_cbranch_vccnz SL_146
BK_147:
  v_mfma_f32_16x16x32_bf16 v[28:31], v[68:71], v[156:159], v[28:31]
  ds_read_b128 v[68:71], v2 offset:9216
  v_mfma_f32_16x16x32_bf16 v[24:27], v[64:67], v[156:159], v[24:27]
  ds_read_b128 v[64:67], v2 offset:8192
  v_mfma_f32_16x16x32_bf16 v[20:23], v[60:63], v[156:159], v[20:23]
  ds_read_b128 v[60:63], v2 offset:7168
  v_mfma_f32_16x16x32_bf16 v[16:19], v[56:59], v[156:159], v[16:19]
  ds_read_b128 v[56:59], v2 offset:6144
  v_mfma_f32_16x16x32_bf16 v[12:15], v[52:55], v[156:159], v[12:15]
  ds_read_b128 v[52:55], v2 offset:5120
  s_waitcnt lgkmcnt(7)
  s_waitcnt vmcnt(16)
  v_mfma_f32_16x16x32_bf16 v[12:15], v[32:35], v[160:163], v[12:15]
  ds_read_b128 v[32:35], v2 offset:10240
  v_mfma_f32_16x16x32_bf16 v[16:19], v[36:39], v[160:163], v[16:19]
  ds_read_b128 v[36:39], v2 offset:11264
  v_mfma_f32_16x16x32_bf16 v[20:23], v[40:43], v[160:163], v[20:23]
  ds_read_b128 v[40:43], v2 offset:12288
  s_waitcnt lgkmcnt(8)
  v_mfma_f32_16x16x32_bf16 v[24:27], v[44:47], v[160:163], v[24:27]
  ds_read_b128 v[44:47], v2 offset:13312
  v_mfma_f32_16x16x32_bf16 v[28:31], v[48:51], v[160:163], v[28:31]
  ds_read_b128 v[48:51], v2 offset:14336
  s_waitcnt lgkmcnt(7)
  s_waitcnt vmcnt(15)
  v_mfma_f32_16x16x32_bf16 v[28:31], v[68:71], v[164:167], v[28:31]
  ds_read_b128 v[68:71], v2 offset:19456
  v_mfma_f32_16x16x32_bf16 v[24:27], v[64:67], v[164:167], v[24:27]
  ds_read_b128 v[64:67], v2 offset:18432
  v_mfma_f32_16x16x32_bf16 v[20:23], v[60:63], v[164:167], v[20:23]
  ds_read_b128 v[60:63], v2 offset:17408
  s_waitcnt lgkmcnt(8)
  v_mfma_f32_16x16x32_bf16 v[16:19], v[56:59], v[164:167], v[16:19]
  ds_read_b128 v[56:59], v2 offset:16384
  v_mfma_f32_16x16x32_bf16 v[12:15], v[52:55], v[164:167], v[12:15]
  ds_read_b128 v[52:55], v2 offset:15360
  s_waitcnt vmcnt(0)
  v_readfirstlane_b32 s63, v5
  s_bitcmp1_b32 s63, 20
  s_cbranch_scc0 SL_129
BK_130:
  ds_read_b32 v9, v8 offset:40
  s_waitcnt lgkmcnt(8)
  v_mfma_f32_16x16x32_bf16 v[12:15], v[32:35], v[168:171], v[12:15]
  ds_read_b128 v[32:35], v2 offset:20480
  v_mfma_f32_16x16x32_bf16 v[16:19], v[36:39], v[168:171], v[16:19]
  ds_read_b128 v[36:39], v2 offset:21504
  v_mfma_f32_16x16x32_bf16 v[20:23], v[40:43], v[168:171], v[20:23]
  ds_read_b128 v[40:43], v2 offset:22528
  s_waitcnt lgkmcnt(9)
  v_mfma_f32_16x16x32_bf16 v[24:27], v[44:47], v[168:171], v[24:27]
  ds_read_b128 v[44:47], v2 offset:23552
  v_mfma_f32_16x16x32_bf16 v[28:31], v[48:51], v[168:171], v[28:31]
  ds_read_b128 v[48:51], v2 offset:24576
  s_add_u32 s62, s66, s72
  buffer_load_dwordx4 v[224:227], v3, s[48:51], s62 offen offset:0 sc1
  s_waitcnt lgkmcnt(5)
  v_cmp_ne_u32 vcc, 0, v9
  s_cbranch_vccnz SL_150
BK_151:
  v_mfma_f32_16x16x32_bf16 v[28:31], v[68:71], v[172:175], v[28:31]
  ds_read_b128 v[68:71], v2 offset:29696
  v_mfma_f32_16x16x32_bf16 v[24:27], v[64:67], v[172:175], v[24:27]
  ds_read_b128 v[64:67], v2 offset:28672
  v_mfma_f32_16x16x32_bf16 v[20:23], v[60:63], v[172:175], v[20:23]
  ds_read_b128 v[60:63], v2 offset:27648
  v_mfma_f32_16x16x32_bf16 v[16:19], v[56:59], v[172:175], v[16:19]
  ds_read_b128 v[56:59], v2 offset:26624
  v_mfma_f32_16x16x32_bf16 v[12:15], v[52:55], v[172:175], v[12:15]
  ds_read_b128 v[52:55], v2 offset:25600
  buffer_load_dwordx4 v[228:231], v3, s[48:51], s62 offen offset:1024 sc1
  s_waitcnt lgkmcnt(7)
  v_mfma_f32_16x16x32_bf16 v[12:15], v[32:35], v[176:179], v[12:15]
  ds_read_b128 v[32:35], v2 offset:30720
  v_mfma_f32_16x16x32_bf16 v[16:19], v[36:39], v[176:179], v[16:19]
  ds_read_b128 v[36:39], v2 offset:31744
  v_mfma_f32_16x16x32_bf16 v[20:23], v[40:43], v[176:179], v[20:23]
  ds_read_b128 v[40:43], v2 offset:32768
  s_waitcnt lgkmcnt(8)
  v_mfma_f32_16x16x32_bf16 v[24:27], v[44:47], v[176:179], v[24:27]
  ds_read_b128 v[44:47], v2 offset:33792
  v_mfma_f32_16x16x32_bf16 v[28:31], v[48:51], v[176:179], v[28:31]
  ds_read_b128 v[48:51], v2 offset:34816
  buffer_load_dwordx4 v[232:235], v3, s[48:51], s62 offen offset:2048 sc1
  s_waitcnt lgkmcnt(7)
  v_mfma_f32_16x16x32_bf16 v[28:31], v[68:71], v[180:183], v[28:31]
  ds_read_b128 v[68:71], v2 offset:39936
  v_mfma_f32_16x16x32_bf16 v[24:27], v[64:67], v[180:183], v[24:27]
  ds_read_b128 v[64:67], v2 offset:38912
  v_mfma_f32_16x16x32_bf16 v[20:23], v[60:63], v[180:183], v[20:23]
  ds_read_b128 v[60:63], v2 offset:37888
  s_waitcnt lgkmcnt(8)
  v_mfma_f32_16x16x32_bf16 v[16:19], v[56:59], v[180:183], v[16:19]
  ds_read_b128 v[56:59], v2 offset:36864
  v_mfma_f32_16x16x32_bf16 v[12:15], v[52:55], v[180:183], v[12:15]
  ds_read_b128 v[52:55], v2 offset:35840
  buffer_load_dwordx4 v[236:239], v3, s[48:51], s62 offen offset:3072 sc1
  s_mov_b64 exec, s[78:79]
  ds_write_b32 v11, v1 offset:224
  s_mov_b64 exec, -1
  v_add_u32 v2, 40960, v2
  ds_read_b32 v9, v8 offset:364
  s_waitcnt lgkmcnt(9)
  v_mfma_f32_16x16x32_bf16 v[12:15], v[32:35], v[184:187], v[12:15]
  ds_read_b128 v[32:35], v2 offset:0
  v_mfma_f32_16x16x32_bf16 v[16:19], v[36:39], v[184:187], v[16:19]
  ds_read_b128 v[36:39], v2 offset:1024
  v_mfma_f32_16x16x32_bf16 v[20:23], v[40:43], v[184:187], v[20:23]
  ds_read_b128 v[40:43], v2 offset:2048
  s_waitcnt lgkmcnt(10)
  v_mfma_f32_16x16x32_bf16 v[24:27], v[44:47], v[184:187], v[24:27]
  ds_read_b128 v[44:47], v2 offset:3072
  v_mfma_f32_16x16x32_bf16 v[28:31], v[48:51], v[184:187], v[28:31]
  ds_read_b128 v[48:51], v2 offset:4096
  s_add_u32 s62, s66, s73
  buffer_load_dwordx4 v[240:243], v3, s[48:51], s62 offen offset:0 sc1
  s_waitcnt lgkmcnt(5)
  v_cmp_ne_u32 vcc, 0, v9
  s_cbranch_vccnz SL_154
BK_155:
  v_mfma_f32_16x16x32_bf16 v[28:31], v[68:71], v[188:191], v[28:31]
  ds_read_b128 v[68:71], v2 offset:9216
  v_mfma_f32_16x16x32_bf16 v[24:27], v[64:67], v[188:191], v[24:27]
  ds_read_b128 v[64:67], v2 offset:8192
  v_mfma_f32_16x16x32_bf16 v[20:23], v[60:63], v[188:191], v[20:23]
  ds_read_b128 v[60:63], v2 offset:7168
  v_mfma_f32_16x16x32_bf16 v[16:19], v[56:59], v[188:191], v[16:19]
  ds_read_b128 v[56:59], v2 offset:6144
  v_mfma_f32_16x16x32_bf16 v[12:15], v[52:55], v[188:191], v[12:15]
  ds_read_b128 v[52:55], v2 offset:5120
  buffer_load_dwordx4 v[244:247], v3, s[48:51], s62 offen offset:1024 sc1
  s_waitcnt lgkmcnt(7)
  v_mfma_f32_16x16x32_bf16 v[12:15], v[32:35], v[192:195], v[12:15]
  ds_read_b128 v[32:35], v2 offset:10240
  v_mfma_f32_16x16x32_bf16 v[16:19], v[36:39], v[192:195], v[16:19]
  ds_read_b128 v[36:39], v2 offset:11264
  v_mfma_f32_16x16x32_bf16 v[20:23], v[40:43], v[192:195], v[20:23]
  ds_read_b128 v[40:43], v2 offset:12288
  s_waitcnt lgkmcnt(8)
  v_mfma_f32_16x16x32_bf16 v[24:27], v[44:47], v[192:195], v[24:27]
  ds_read_b128 v[44:47], v2 offset:13312
  v_mfma_f32_16x16x32_bf16 v[28:31], v[48:51], v[192:195], v[28:31]
  ds_read_b128 v[48:51], v2 offset:14336
  buffer_load_dwordx4 v[248:251], v3, s[48:51], s62 offen offset:2048 sc1
  s_waitcnt lgkmcnt(7)
  v_mfma_f32_16x16x32_bf16 v[28:31], v[68:71], v[196:199], v[28:31]
  ds_read_b128 v[68:71], v2 offset:19456
  v_mfma_f32_16x16x32_bf16 v[24:27], v[64:67], v[196:199], v[24:27]
  ds_read_b128 v[64:67], v2 offset:18432
  v_mfma_f32_16x16x32_bf16 v[20:23], v[60:63], v[196:199], v[20:23]
  ds_read_b128 v[60:63], v2 offset:17408
  s_waitcnt lgkmcnt(8)
  v_mfma_f32_16x16x32_bf16 v[16:19], v[56:59], v[196:199], v[16:19]
  ds_read_b128 v[56:59], v2 offset:16384
  v_mfma_f32_16x16x32_bf16 v[12:15], v[52:55], v[196:199], v[12:15]
  ds_read_b128 v[52:55], v2 offset:15360
  buffer_load_dwordx4 v[252:255], v3, s[48:51], s62 offen offset:3072 sc1
  ds_read_b32 v9, v8 offset:44
  s_waitcnt lgkmcnt(8)
  v_mfma_f32_16x16x32_bf16 v[12:15], v[32:35], v[200:203], v[12:15]
  ds_read_b128 v[32:35], v2 offset:20480
  v_mfma_f32_16x16x32_bf16 v[16:19], v[36:39], v[200:203], v[16:19]
  ds_read_b128 v[36:39], v2 offset:21504
  v_mfma_f32_16x16x32_bf16 v[20:23], v[40:43], v[200:203], v[20:23]
  ds_read_b128 v[40:43], v2 offset:22528
  s_waitcnt lgkmcnt(9)
  v_mfma_f32_16x16x32_bf16 v[24:27], v[44:47], v[200:203], v[24:27]
  ds_read_b128 v[44:47], v2 offset:23552
  v_mfma_f32_16x16x32_bf16 v[28:31], v[48:51], v[200:203], v[28:31]
  ds_read_b128 v[48:51], v2 offset:24576
  s_add_u32 s62, s66, s74
  buffer_load_dwordx4 v[72:75], v3, s[48:51], s62 offen offset:0 sc1
  s_waitcnt lgkmcnt(5)
  v_cmp_ne_u32 vcc, 0, v9
  s_cbranch_vccnz SL_158
BK_159:
  v_mfma_f32_16x16x32_bf16 v[28:31], v[68:71], v[204:207], v[28:31]
  ds_read_b128 v[68:71], v2 offset:29696
  v_mfma_f32_16x16x32_bf16 v[24:27], v[64:67], v[204:207], v[24:27]
  ds_read_b128 v[64:67], v2 offset:28672
  v_mfma_f32_16x16x32_bf16 v[20:23], v[60:63], v[204:207], v[20:23]
  ds_read_b128 v[60:63], v2 offset:27648
  v_mfma_f32_16x16x32_bf16 v[16:19], v[56:59], v[204:207], v[16:19]
  ds_read_b128 v[56:59], v2 offset:26624
  v_mfma_f32_16x16x32_bf16 v[12:15], v[52:55], v[204:207], v[12:15]
  ds_read_b128 v[52:55], v2 offset:25600
  buffer_load_dwordx4 v[76:79], v3, s[48:51], s62 offen offset:1024 sc1
  s_waitcnt lgkmcnt(7)
  v_mfma_f32_16x16x32_bf16 v[12:15], v[32:35], v[208:211], v[12:15]
  ds_read_b128 v[32:35], v2 offset:30720
  v_mfma_f32_16x16x32_bf16 v[16:19], v[36:39], v[208:211], v[16:19]
  ds_read_b128 v[36:39], v2 offset:31744
  v_mfma_f32_16x16x32_bf16 v[20:23], v[40:43], v[208:211], v[20:23]
  ds_read_b128 v[40:43], v2 offset:32768
  s_waitcnt lgkmcnt(8)
  v_mfma_f32_16x16x32_bf16 v[24:27], v[44:47], v[208:211], v[24:27]
  ds_read_b128 v[44:47], v2 offset:33792
  v_mfma_f32_16x16x32_bf16 v[28:31], v[48:51], v[208:211], v[28:31]
  ds_read_b128 v[48:51], v2 offset:34816
  buffer_load_dwordx4 v[80:83], v3, s[48:51], s62 offen offset:2048 sc1
  s_waitcnt lgkmcnt(7)
  v_mfma_f32_16x16x32_bf16 v[28:31], v[68:71], v[212:215], v[28:31]
  ds_read_b128 v[68:71], v2 offset:39936
  v_mfma_f32_16x16x32_bf16 v[24:27], v[64:67], v[212:215], v[24:27]
  ds_read_b128 v[64:67], v2 offset:38912
  v_mfma_f32_16x16x32_bf16 v[20:23], v[60:63], v[212:215], v[20:23]
  ds_read_b128 v[60:63], v2 offset:37888
  s_waitcnt lgkmcnt(8)
  v_mfma_f32_16x16x32_bf16 v[16:19], v[56:59], v[212:215], v[16:19]
  ds_read_b128 v[56:59], v2 offset:36864
  v_mfma_f32_16x16x32_bf16 v[12:15], v[52:55], v[212:215], v[12:15]
  ds_read_b128 v[52:55], v2 offset:35840
  buffer_load_dwordx4 v[84:87], v3, s[48:51], s62 offen offset:3072 sc1
  v_subrev_u32 v2, 81920, v2
  ds_read_b32 v9, v8 offset:368
  s_waitcnt lgkmcnt(8)
  v_mfma_f32_16x16x32_bf16 v[12:15], v[32:35], v[216:219], v[12:15]
  ds_read_b128 v[32:35], v2 offset:0
  v_mfma_f32_16x16x32_bf16 v[16:19], v[36:39], v[216:219], v[16:19]
  ds_read_b128 v[36:39], v2 offset:1024
  v_mfma_f32_16x16x32_bf16 v[20:23], v[40:43], v[216:219], v[20:23]
  ds_read_b128 v[40:43], v2 offset:2048
  s_waitcnt lgkmcnt(9)
  v_mfma_f32_16x16x32_bf16 v[24:27], v[44:47], v[216:219], v[24:27]
  ds_read_b128 v[44:47], v2 offset:3072
  v_mfma_f32_16x16x32_bf16 v[28:31], v[48:51], v[216:219], v[28:31]
  ds_read_b128 v[48:51], v2 offset:4096
  s_add_u32 s62, s66, s75
  buffer_load_dwordx4 v[88:91], v3, s[48:51], s62 offen offset:0 sc1
  s_waitcnt lgkmcnt(5)
  v_cmp_ne_u32 vcc, 0, v9
  s_cbranch_vccnz SL_162
BK_163:
  v_mfma_f32_16x16x32_bf16 v[28:31], v[68:71], v[220:223], v[28:31]
  ds_read_b128 v[68:71], v2 offset:9216
  v_mfma_f32_16x16x32_bf16 v[24:27], v[64:67], v[220:223], v[24:27]
  ds_read_b128 v[64:67], v2 offset:8192
  v_mfma_f32_16x16x32_bf16 v[20:23], v[60:63], v[220:223], v[20:23]
  ds_read_b128 v[60:63], v2 offset:7168
  v_mfma_f32_16x16x32_bf16 v[16:19], v[56:59], v[220:223], v[16:19]
  ds_read_b128 v[56:59], v2 offset:6144
  v_mfma_f32_16x16x32_bf16 v[12:15], v[52:55], v[220:223], v[12:15]
  ds_read_b128 v[52:55], v2 offset:5120
  buffer_load_dwordx4 v[92:95], v3, s[48:51], s62 offen offset:1024 sc1
  s_waitcnt lgkmcnt(7)
  s_waitcnt vmcnt(13)
  v_mfma_f32_16x16x32_bf16 v[12:15], v[32:35], v[224:227], v[12:15]
  ds_read_b128 v[32:35], v2 offset:10240
  v_mfma_f32_16x16x32_bf16 v[16:19], v[36:39], v[224:227], v[16:19]
  ds_read_b128 v[36:39], v2 offset:11264
  v_mfma_f32_16x16x32_bf16 v[20:23], v[40:43], v[224:227], v[20:23]
  ds_read_b128 v[40:43], v2 offset:12288
  s_waitcnt lgkmcnt(8)
  v_mfma_f32_16x16x32_bf16 v[24:27], v[44:47], v[224:227], v[24:27]
  ds_read_b128 v[44:47], v2 offset:13312
  v_mfma_f32_16x16x32_bf16 v[28:31], v[48:51], v[224:227], v[28:31]
  ds_read_b128 v[48:51], v2 offset:14336
  buffer_load_dwordx4 v[96:99], v3, s[48:51], s62 offen offset:2048 sc1
  s_waitcnt lgkmcnt(7)
  s_waitcnt vmcnt(13)
  v_mfma_f32_16x16x32_bf16 v[28:31], v[68:71], v[228:231], v[28:31]
  ds_read_b128 v[68:71], v2 offset:19456
  v_mfma_f32_16x16x32_bf16 v[24:27], v[64:67], v[228:231], v[24:27]
  ds_read_b128 v[64:67], v2 offset:18432
  v_mfma_f32_16x16x32_bf16 v[20:23], v[60:63], v[228:231], v[20:23]
  ds_read_b128 v[60:63], v2 offset:17408
  s_waitcnt lgkmcnt(8)
  v_mfma_f32_16x16x32_bf16 v[16:19], v[56:59], v[228:231], v[16:19]
  ds_read_b128 v[56:59], v2 offset:16384
  v_mfma_f32_16x16x32_bf16 v[12:15], v[52:55], v[228:231], v[12:15]
  ds_read_b128 v[52:55], v2 offset:15360
  buffer_load_dwordx4 v[100:103], v3, s[48:51], s62 offen offset:3072 sc1
  ds_read_b32 v9, v8 offset:48
  s_waitcnt lgkmcnt(8)
  s_waitcnt vmcnt(13)
  v_mfma_f32_16x16x32_bf16 v[12:15], v[32:35], v[232:235], v[12:15]
  ds_read_b128 v[32:35], v2 offset:20480
  v_mfma_f32_16x16x32_bf16 v[16:19], v[36:39], v[232:235], v[16:19]
  ds_read_b128 v[36:39], v2 offset:21504
  v_mfma_f32_16x16x32_bf16 v[20:23], v[40:43], v[232:235], v[20:23]
  ds_read_b128 v[40:43], v2 offset:22528
  s_waitcnt lgkmcnt(9)
  v_mfma_f32_16x16x32_bf16 v[24:27], v[44:47], v[232:235], v[24:27]
  ds_read_b128 v[44:47], v2 offset:23552
  v_mfma_f32_16x16x32_bf16 v[28:31], v[48:51], v[232:235], v[28:31]
  ds_read_b128 v[48:51], v2 offset:24576
  v_lshrrev_b32 v4, 2, v0
  v_lshlrev_b32 v4, 7, v4
  v_bfe_u32 v5, v0, 1, 1
  v_lshl_add_u32 v4, v5, 6, v4
  v_and_b32 v5, 1, v0
  v_lshl_add_u32 v4, v5, 3, v4
  s_lshl_b32 s63, s3, 4
  s_add_u32 s63, s63, 1536
  v_add_u32 v4, s63, v4
  v_and_b32 v6, 15, v0
  v_lshrrev_b32 v7, 4, v0
  v_mul_u32_u24 v10, 160, v6
  v_lshl_add_u32 v10, v7, 3, v10
  s_mul_i32 s63, s3, 2560
  s_add_u32 s63, s63, 15360
  v_add_u32 v10, s63, v10
  s_and_b32 s76, s5, 1
  s_mul_i32 s63, s76, 128
  v_subrev_u32 v136, s63, v10
  s_mul_i32 s63, s76, 32
  v_add_u32 v10, s63, v10
  s_mul_i32 s63, s76, 8192
  v_subrev_u32 v137, s63, v4
  v_add_u32 v137, 8192, v137
  s_mul_i32 s63, s76, 2048
  v_add_u32 v4, s63, v4
  ds_read_b64 v[114:115], v10 offset:0
  ds_read_b64 v[118:119], v10 offset:32
  ds_read_b64 v[122:123], v10 offset:64
  ds_read_b64 v[126:127], v10 offset:96
  ds_read_b64 v[130:131], v136 offset:128
  s_waitcnt lgkmcnt(10)
  v_cmp_ne_u32 vcc, 0, v9
  s_cbranch_vccnz SL_166
BK_167:
  s_waitcnt vmcnt(12)
  v_mfma_f32_16x16x32_bf16 v[28:31], v[68:71], v[236:239], v[28:31]
  ds_read_b128 v[68:71], v2 offset:29696
  v_mfma_f32_16x16x32_bf16 v[24:27], v[64:67], v[236:239], v[24:27]
  ds_read_b128 v[64:67], v2 offset:28672
  v_mfma_f32_16x16x32_bf16 v[20:23], v[60:63], v[236:239], v[20:23]
  ds_read_b128 v[60:63], v2 offset:27648
  v_mfma_f32_16x16x32_bf16 v[16:19], v[56:59], v[236:239], v[16:19]
  ds_read_b128 v[56:59], v2 offset:26624
  v_mfma_f32_16x16x32_bf16 v[12:15], v[52:55], v[236:239], v[12:15]
  ds_read_b128 v[52:55], v2 offset:25600
  s_mul_i32 s63, s67, 20480
  s_mul_i32 s70, s5, 160
  s_add_u32 s63, s63, s70
  v_mul_u32_u24 v6, 1280, v6
  v_add_u32 v6, s63, v6
  v_and_b32 v5, 1, v7
  v_lshl_add_u32 v5, v5, 5, v6
  v_lshrrev_b32 v10, 1, v7
  v_lshl_add_u32 v5, v10, 4, v5
  v_lshl_add_u32 v6, v10, 4, v6
  s_mul_i32 s63, s76, 32
  v_add_u32 v5, s63, v5
  s_mul_i32 s63, s76, 128
  v_subrev_u32 v6, s63, v6
  s_waitcnt lgkmcnt(12)
  s_waitcnt vmcnt(11)
  v_mfma_f32_16x16x32_bf16 v[12:15], v[32:35], v[240:243], v[12:15]
  ds_read_b128 v[32:35], v2 offset:30720
  v_mfma_f32_16x16x32_bf16 v[16:19], v[36:39], v[240:243], v[16:19]
  ds_read_b128 v[36:39], v2 offset:31744
  v_mfma_f32_16x16x32_bf16 v[20:23], v[40:43], v[240:243], v[20:23]
  ds_read_b128 v[40:43], v2 offset:32768
  s_waitcnt lgkmcnt(13)
  v_mfma_f32_16x16x32_bf16 v[24:27], v[44:47], v[240:243], v[24:27]
  ds_read_b128 v[44:47], v2 offset:33792
  v_mfma_f32_16x16x32_bf16 v[28:31], v[48:51], v[240:243], v[28:31]
  ds_read_b128 v[48:51], v2 offset:34816
  v_and_b32 v10, 1, v0
  v_lshlrev_b32 v10, 4, v10
  v_mov_b32 v132, 0x3f80
  v_lshlrev_b32 v10, v10, v132
  v_bfe_u32 v132, v0, 1, 3
  v_lshlrev_b32 v7, 1, v7
  v_sub_u32 v7, v132, v7
  v_cmp_eq_u32 s[70:71], 0, v7
  v_cmp_eq_u32 vcc, 1, v7
  s_nop 0
  v_cndmask_b32 v132, 0, v10, s[70:71]
  v_cndmask_b32 v134, 0, v10, s[70:71]
  v_cndmask_b32 v133, 0, v10, vcc
  v_cndmask_b32 v135, 0, v10, vcc
  s_waitcnt lgkmcnt(7)
  s_waitcnt vmcnt(10)
  v_mfma_f32_16x16x32_bf16 v[28:31], v[68:71], v[244:247], v[28:31]
  ds_read_b128 v[68:71], v2 offset:39936
  v_mfma_f32_16x16x32_bf16 v[24:27], v[64:67], v[244:247], v[24:27]
  ds_read_b128 v[64:67], v2 offset:38912
  v_mfma_f32_16x16x32_bf16 v[20:23], v[60:63], v[244:247], v[20:23]
  ds_read_b128 v[60:63], v2 offset:37888
  s_waitcnt lgkmcnt(8)
  v_mfma_f32_16x16x32_bf16 v[16:19], v[56:59], v[244:247], v[16:19]
  ds_read_b128 v[56:59], v2 offset:36864
  v_mfma_f32_16x16x32_bf16 v[12:15], v[52:55], v[244:247], v[12:15]
  ds_read_b128 v[52:55], v2 offset:35840
  s_waitcnt lgkmcnt(7)
  s_waitcnt vmcnt(9)
  v_mfma_f32_16x16x32_bf16 v[12:15], v[32:35], v[248:251], v[12:15]
  ds_read_b128 v[32:35], v3 offset:25600
  v_mfma_f32_16x16x32_bf16 v[16:19], v[36:39], v[248:251], v[16:19]
  ds_read_b128 v[36:39], v3 offset:26624
  v_mfma_f32_16x16x32_bf16 v[20:23], v[40:43], v[248:251], v[20:23]
  ds_read_b128 v[40:43], v3 offset:27648
  s_waitcnt lgkmcnt(8)
  v_mfma_f32_16x16x32_bf16 v[24:27], v[44:47], v[248:251], v[24:27]
  ds_read_b128 v[44:47], v3 offset:28672
  v_mfma_f32_16x16x32_bf16 v[28:31], v[48:51], v[248:251], v[28:31]
  ds_read_b128 v[48:51], v3 offset:29696
  s_waitcnt lgkmcnt(7)
  s_waitcnt vmcnt(8)
  v_mfma_f32_16x16x32_bf16 v[28:31], v[68:71], v[252:255], v[28:31]
  ds_read_b128 v[68:71], v3 offset:34816
  v_mfma_f32_16x16x32_bf16 v[24:27], v[64:67], v[252:255], v[24:27]
  ds_read_b128 v[64:67], v3 offset:33792
  v_mfma_f32_16x16x32_bf16 v[20:23], v[60:63], v[252:255], v[20:23]
  ds_read_b128 v[60:63], v3 offset:32768
  s_waitcnt lgkmcnt(8)
  v_mfma_f32_16x16x32_bf16 v[16:19], v[56:59], v[252:255], v[16:19]
  ds_read_b128 v[56:59], v3 offset:31744
  v_mfma_f32_16x16x32_bf16 v[12:15], v[52:55], v[252:255], v[12:15]
  ds_read_b128 v[52:55], v3 offset:30720
  s_waitcnt lgkmcnt(7)
  s_waitcnt vmcnt(2)
  v_mfma_f32_16x16x32_bf16 v[12:15], v[32:35], v[92:95], v[12:15]
  ds_read_b128 v[32:35], v3 offset:35840
  v_mfma_f32_16x16x32_bf16 v[16:19], v[36:39], v[92:95], v[16:19]
  ds_read_b128 v[36:39], v3 offset:36864
  v_mfma_f32_16x16x32_bf16 v[20:23], v[40:43], v[92:95], v[20:23]
  ds_read_b128 v[40:43], v3 offset:37888
  s_waitcnt lgkmcnt(8)
  v_mfma_f32_16x16x32_bf16 v[24:27], v[44:47], v[92:95], v[24:27]
  ds_read_b128 v[44:47], v3 offset:38912
  v_mfma_f32_16x16x32_bf16 v[28:31], v[48:51], v[92:95], v[28:31]
  ds_read_b128 v[48:51], v3 offset:39936
  v_add_u32 v2, 40960, v2
  ds_read_b32 v9, v8 offset:372
  s_waitcnt lgkmcnt(8)
  s_waitcnt vmcnt(1)
  v_mfma_f32_16x16x32_bf16 v[28:31], v[68:71], v[96:99], v[28:31]
  ds_read_b128 v[68:71], v2 offset:4096
  v_mfma_f32_16x16x32_bf16 v[24:27], v[64:67], v[96:99], v[24:27]
  ds_read_b128 v[64:67], v2 offset:3072
  v_mfma_f32_16x16x32_bf16 v[20:23], v[60:63], v[96:99], v[20:23]
  ds_read_b128 v[60:63], v2 offset:2048
  s_waitcnt lgkmcnt(9)
  v_mfma_f32_16x16x32_bf16 v[16:19], v[56:59], v[96:99], v[16:19]
  ds_read_b128 v[56:59], v2 offset:1024
  v_mfma_f32_16x16x32_bf16 v[12:15], v[52:55], v[96:99], v[12:15]
  ds_read_b128 v[52:55], v2 offset:0
  s_waitcnt lgkmcnt(5)
  v_cmp_ne_u32 vcc, 0, v9
  s_cbranch_vccnz SL_170
BK_171:
  s_waitcnt vmcnt(0)
  v_mfma_f32_16x16x32_bf16 v[12:15], v[32:35], v[100:103], v[12:15]
  ds_read_b128 v[32:35], v2 offset:5120
  v_mfma_f32_16x16x32_bf16 v[16:19], v[36:39], v[100:103], v[16:19]
  ds_read_b128 v[36:39], v2 offset:6144
  v_mfma_f32_16x16x32_bf16 v[20:23], v[40:43], v[100:103], v[20:23]
  ds_read_b128 v[40:43], v2 offset:7168
  v_mfma_f32_16x16x32_bf16 v[24:27], v[44:47], v[100:103], v[24:27]
  ds_read_b128 v[44:47], v2 offset:8192
  v_mfma_f32_16x16x32_bf16 v[28:31], v[48:51], v[100:103], v[28:31]
  ds_read_b128 v[48:51], v2 offset:9216
  ds_read_b32 v9, v8 offset:52
  s_waitcnt lgkmcnt(8)
  v_mfma_f32_16x16x32_bf16 v[28:31], v[68:71], v[72:75], v[28:31]
  ds_read_b128 v[68:71], v2 offset:14336
  v_mfma_f32_16x16x32_bf16 v[24:27], v[64:67], v[72:75], v[24:27]
  ds_read_b128 v[64:67], v2 offset:13312
  v_mfma_f32_16x16x32_bf16 v[20:23], v[60:63], v[72:75], v[20:23]
  ds_read_b128 v[60:63], v2 offset:12288
  s_waitcnt lgkmcnt(9)
  v_mfma_f32_16x16x32_bf16 v[16:19], v[56:59], v[72:75], v[16:19]
  ds_read_b128 v[56:59], v2 offset:11264
  v_mfma_f32_16x16x32_bf16 v[12:15], v[52:55], v[72:75], v[12:15]
  ds_read_b128 v[52:55], v2 offset:10240
  s_waitcnt lgkmcnt(5)
  v_cmp_ne_u32 vcc, 0, v9
  s_cbranch_vccnz SL_174
BK_175:
  v_mfma_f32_16x16x32_bf16 v[12:15], v[32:35], v[76:79], v[12:15]
  ds_read_b128 v[32:35], v2 offset:15360
  v_mfma_f32_16x16x32_bf16 v[16:19], v[36:39], v[76:79], v[16:19]
  ds_read_b128 v[36:39], v2 offset:16384
  v_mfma_f32_16x16x32_bf16 v[20:23], v[40:43], v[76:79], v[20:23]
  ds_read_b128 v[40:43], v2 offset:17408
  v_mfma_f32_16x16x32_bf16 v[24:27], v[44:47], v[76:79], v[24:27]
  ds_read_b128 v[44:47], v2 offset:18432
  v_mfma_f32_16x16x32_bf16 v[28:31], v[48:51], v[76:79], v[28:31]
  ds_read_b128 v[48:51], v2 offset:19456
  s_waitcnt lgkmcnt(7)
  v_mfma_f32_16x16x32_bf16 v[28:31], v[68:71], v[80:83], v[28:31]
  ds_read_b128 v[68:71], v2 offset:24576
  v_mfma_f32_16x16x32_bf16 v[24:27], v[64:67], v[80:83], v[24:27]
  ds_read_b128 v[64:67], v2 offset:23552
  v_mfma_f32_16x16x32_bf16 v[20:23], v[60:63], v[80:83], v[20:23]
  ds_read_b128 v[60:63], v2 offset:22528
  s_waitcnt lgkmcnt(8)
  v_mfma_f32_16x16x32_bf16 v[16:19], v[56:59], v[80:83], v[16:19]
  ds_read_b128 v[56:59], v2 offset:21504
  v_mfma_f32_16x16x32_bf16 v[12:15], v[52:55], v[80:83], v[12:15]
  ds_read_b128 v[52:55], v2 offset:20480
  s_waitcnt lgkmcnt(7)
  v_mfma_f32_16x16x32_bf16 v[12:15], v[32:35], v[84:87], v[12:15]
  ds_read_b32 v9, v8 offset:56
  ds_read_b64_tr_b16 v[112:113], v4 offset:0
  v_mfma_f32_16x16x32_bf16 v[16:19], v[36:39], v[84:87], v[16:19]
  ds_read_b64_tr_b16 v[116:117], v4 offset:2048
  v_mfma_f32_16x16x32_bf16 v[20:23], v[40:43], v[84:87], v[20:23]
  ds_read_b64_tr_b16 v[120:121], v4 offset:4096
  s_waitcnt lgkmcnt(9)
  v_mfma_f32_16x16x32_bf16 v[24:27], v[44:47], v[84:87], v[24:27]
  ds_read_b64_tr_b16 v[124:125], v4 offset:6144
  v_mfma_f32_16x16x32_bf16 v[28:31], v[48:51], v[84:87], v[28:31]
  ds_read_b64_tr_b16 v[128:129], v137 offset:0
  s_waitcnt lgkmcnt(8)
  v_mfma_f32_16x16x32_bf16 v[28:31], v[68:71], v[88:91], v[28:31]
  v_mfma_f32_16x16x32_bf16 v[24:27], v[64:67], v[88:91], v[24:27]
  v_mfma_f32_16x16x32_bf16 v[20:23], v[60:63], v[88:91], v[20:23]
  s_waitcnt lgkmcnt(6)
  v_mfma_f32_16x16x32_bf16 v[16:19], v[56:59], v[88:91], v[16:19]
  v_mfma_f32_16x16x32_bf16 v[12:15], v[52:55], v[88:91], v[12:15]
  s_waitcnt lgkmcnt(5)
  v_cmp_ne_u32 vcc, 0, v9
  s_cbranch_vccnz SL_178
BK_179:
  s_waitcnt lgkmcnt(0)
  v_mfma_f32_16x16x32_bf16 v[28:31], v[132:135], v[128:131], v[28:31]
  v_mfma_f32_16x16x32_bf16 v[12:15], v[132:135], v[112:115], v[12:15]
  v_mfma_f32_16x16x32_bf16 v[16:19], v[132:135], v[116:119], v[16:19]
  v_mfma_f32_16x16x32_bf16 v[20:23], v[132:135], v[120:123], v[20:23]
  v_mfma_f32_16x16x32_bf16 v[24:27], v[132:135], v[124:127], v[24:27]
  s_nop 3
  v_cvt_pk_bf16_f32 v168, v28, v29
  v_cvt_pk_bf16_f32 v169, v30, v31
  v_cvt_pk_bf16_f32 v170, v28, v29
  v_cvt_pk_bf16_f32 v171, v30, v31
  v_cvt_pk_bf16_f32 v160, v12, v13
  v_cvt_pk_bf16_f32 v161, v14, v15
  v_permlane16_swap_b32 v168, v170
  v_permlane16_swap_b32 v169, v171
  s_mov_b32 exec_lo, 0xffff
  s_mov_b32 exec_hi, 0xffff
  global_store_dwordx4 v6, v[168:171], s[40:41] offset:128 sc1
  s_mov_b64 exec, -1
  v_cvt_pk_bf16_f32 v162, v16, v17
  v_cvt_pk_bf16_f32 v163, v18, v19
  v_cvt_pk_bf16_f32 v164, v20, v21
  v_cvt_pk_bf16_f32 v165, v22, v23
  v_permlane16_swap_b32 v160, v162
  v_permlane16_swap_b32 v161, v163
  global_store_dwordx4 v5, v[160:163], s[40:41] offset:0 sc1
  v_cvt_pk_bf16_f32 v166, v24, v25
  v_cvt_pk_bf16_f32 v167, v26, v27
  s_nop 0
  v_permlane16_swap_b32 v164, v166
  v_permlane16_swap_b32 v165, v167
  global_store_dwordx4 v5, v[164:167], s[40:41] offset:64 sc1
  s_endpgm
SL_69:
SP_71:
  ds_read_b32 v19, v11 offset:80
  s_waitcnt lgkmcnt(0)
  v_cmp_ne_u32 vcc, 0, v19
  s_cbranch_vccz SO_72
  s_sleep 2
  s_sub_u32 s12, s12, 1
  s_cbranch_scc0 SP_71
  s_mov_b32 s12, 0
SO_72:
  ds_read_b64 v[20:21], v30 offset:0
  ds_read_b64 v[22:23], v30 offset:512
  s_waitcnt lgkmcnt(0)
  s_branch BK_70
SL_75:
  v_and_b32 v29, 7, v0
  v_lshlrev_b32 v29, 2, v29
SP_77:
  global_load_dword v28, v29, s[42:43] sc1
  s_waitcnt vmcnt(0)
  v_cmp_eq_u32 vcc, 0, v28
  s_cbranch_vccz SO_78
  s_sleep 1
  s_sub_u32 s12, s12, 1
  s_cbranch_scc0 SP_77
  s_mov_b32 s12, 0
SO_78:
  s_branch BK_76
SL_79:
SP_81:
  ds_read_b32 v9, v8 offset:8
  s_waitcnt lgkmcnt(0)
  v_cmp_ne_u32 vcc, 0, v9
  s_cbranch_vccz SO_82
  s_sleep 2
  s_sub_u32 s12, s12, 1
  s_cbranch_scc0 SP_81
  s_mov_b32 s12, 0
SO_82:
  ds_read_b64_tr_b16 v[44:45], v2 offset:26624
  ds_read_b64_tr_b16 v[46:47], v2 offset:27136
  ds_read_b64_tr_b16 v[40:41], v2 offset:24576
  ds_read_b64_tr_b16 v[42:43], v2 offset:25088
  s_waitcnt lgkmcnt(0)
  s_branch BK_80
SL_83:
SP_85:
  ds_read_b32 v9, v8 offset:332
  s_waitcnt lgkmcnt(0)
  v_cmp_ne_u32 vcc, 0, v9
  s_cbranch_vccz SO_86
  s_sleep 2
  s_sub_u32 s12, s12, 1
  s_cbranch_scc0 SP_85
  s_mov_b32 s12, 0
SO_86:
  ds_read_b64_tr_b16 v[52:53], v2 offset:2048
  ds_read_b64_tr_b16 v[54:55], v2 offset:2560
  ds_read_b64_tr_b16 v[48:49], v2 offset:0
  ds_read_b64_tr_b16 v[50:51], v2 offset:512
  s_waitcnt lgkmcnt(0)
  s_branch BK_84
SL_87:
SP_89:
  ds_read_b32 v9, v8 offset:12
  s_waitcnt lgkmcnt(0)
  v_cmp_ne_u32 vcc, 0, v9
  s_cbranch_vccz SO_90
  s_sleep 2
  s_sub_u32 s12, s12, 1
  s_cbranch_scc0 SP_89
  s_mov_b32 s12, 0
SO_90:
  ds_read_b64_tr_b16 v[52:53], v2 offset:26624
  ds_read_b64_tr_b16 v[54:55], v2 offset:27136
  ds_read_b64_tr_b16 v[48:49], v2 offset:24576
  ds_read_b64_tr_b16 v[50:51], v2 offset:25088
  s_waitcnt lgkmcnt(0)
  s_branch BK_88
SL_91:
SP_93:
  ds_read_b32 v9, v8 offset:336
  s_waitcnt lgkmcnt(0)
  v_cmp_ne_u32 vcc, 0, v9
  s_cbranch_vccz SO_94
  s_sleep 2
  s_sub_u32 s12, s12, 1
  s_cbranch_scc0 SP_93
  s_mov_b32 s12, 0
SO_94:
  ds_read_b64_tr_b16 v[60:61], v2 offset:2048
  ds_read_b64_tr_b16 v[62:63], v2 offset:2560
  ds_read_b64_tr_b16 v[56:57], v2 offset:0
  ds_read_b64_tr_b16 v[58:59], v2 offset:512
  s_waitcnt lgkmcnt(0)
  s_branch BK_92
SL_95:
SP_97:
  ds_read_b32 v9, v8 offset:16
  s_waitcnt lgkmcnt(0)
  v_cmp_ne_u32 vcc, 0, v9
  s_cbranch_vccz SO_98
  s_sleep 2
  s_sub_u32 s12, s12, 1
  s_cbranch_scc0 SP_97
  s_mov_b32 s12, 0
SO_98:
  ds_read_b64_tr_b16 v[60:61], v2 offset:26624
  ds_read_b64_tr_b16 v[62:63], v2 offset:27136
  ds_read_b64_tr_b16 v[56:57], v2 offset:24576
  ds_read_b64_tr_b16 v[58:59], v2 offset:25088
  s_waitcnt lgkmcnt(0)
  s_branch BK_96
SL_99:
SP_101:
  ds_read_b32 v9, v8 offset:340
  s_waitcnt lgkmcnt(0)
  v_cmp_ne_u32 vcc, 0, v9
  s_cbranch_vccz SO_102
  s_sleep 2
  s_sub_u32 s12, s12, 1
  s_cbranch_scc0 SP_101
  s_mov_b32 s12, 0
SO_102:
  ds_read_b64_tr_b16 v[44:45], v2 offset:2048
  ds_read_b64_tr_b16 v[46:47], v2 offset:2560
  ds_read_b64_tr_b16 v[40:41], v2 offset:0
  ds_read_b64_tr_b16 v[42:43], v2 offset:512
  s_waitcnt lgkmcnt(0)
  s_branch BK_100
SL_103:
SP_105:
  ds_read_b32 v9, v8 offset:20
  s_waitcnt lgkmcnt(0)
  v_cmp_ne_u32 vcc, 0, v9
  s_cbranch_vccz SO_106
  s_sleep 2
  s_sub_u32 s12, s12, 1
  s_cbranch_scc0 SP_105
  s_mov_b32 s12, 0
SO_106:
  ds_read_b64_tr_b16 v[44:45], v2 offset:26624
  ds_read_b64_tr_b16 v[46:47], v2 offset:27136
  ds_read_b64_tr_b16 v[40:41], v2 offset:24576
  ds_read_b64_tr_b16 v[42:43], v2 offset:25088
  s_waitcnt lgkmcnt(0)
  s_branch BK_104
SL_107:
SP_109:
  ds_read_b32 v9, v8 offset:344
  s_waitcnt lgkmcnt(0)
  v_cmp_ne_u32 vcc, 0, v9
  s_cbranch_vccz SO_110
  s_sleep 2
  s_sub_u32 s12, s12, 1
  s_cbranch_scc0 SP_109
  s_mov_b32 s12, 0
SO_110:
  ds_read_b64_tr_b16 v[52:53], v2 offset:2048
  ds_read_b64_tr_b16 v[54:55], v2 offset:2560
  ds_read_b64_tr_b16 v[48:49], v2 offset:0
  ds_read_b64_tr_b16 v[50:51], v2 offset:512
  s_waitcnt lgkmcnt(0)
  s_branch BK_108
SL_111:
SP_113:
  ds_read_b32 v9, v8 offset:24
  s_waitcnt lgkmcnt(0)
  v_cmp_ne_u32 vcc, 0, v9
  s_cbranch_vccz SO_114
  s_sleep 2
  s_sub_u32 s12, s12, 1
  s_cbranch_scc0 SP_113
  s_mov_b32 s12, 0
SO_114:
  ds_read_b64_tr_b16 v[52:53], v2 offset:26624
  ds_read_b64_tr_b16 v[54:55], v2 offset:27136
  ds_read_b64_tr_b16 v[48:49], v2 offset:24576
  ds_read_b64_tr_b16 v[50:51], v2 offset:25088
  s_waitcnt lgkmcnt(0)
  s_branch BK_112
SL_115:
SP_117:
  ds_read_b32 v9, v8 offset:348
  s_waitcnt lgkmcnt(0)
  v_cmp_ne_u32 vcc, 0, v9
  s_cbranch_vccz SO_118
  s_sleep 2
  s_sub_u32 s12, s12, 1
  s_cbranch_scc0 SP_117
  s_mov_b32 s12, 0
SO_118:
  ds_read_b64_tr_b16 v[60:61], v2 offset:2048
  ds_read_b64_tr_b16 v[62:63], v2 offset:2560
  ds_read_b64_tr_b16 v[56:57], v2 offset:0
  ds_read_b64_tr_b16 v[58:59], v2 offset:512
  s_waitcnt lgkmcnt(0)
  s_branch BK_116
SL_119:
SP_121:
  ds_read_b32 v9, v8 offset:28
  s_waitcnt lgkmcnt(0)
  v_cmp_ne_u32 vcc, 0, v9
  s_cbranch_vccz SO_122
  s_sleep 2
  s_sub_u32 s12, s12, 1
  s_cbranch_scc0 SP_121
  s_mov_b32 s12, 0
SO_122:
  ds_read_b64_tr_b16 v[60:61], v2 offset:26624
  ds_read_b64_tr_b16 v[62:63], v2 offset:27136
  ds_read_b64_tr_b16 v[56:57], v2 offset:24576
  ds_read_b64_tr_b16 v[58:59], v2 offset:25088
  s_waitcnt lgkmcnt(0)
  s_branch BK_120
SL_123:
  v_mov_b32 v5, 0
  s_mov_b64 exec, 1
  buffer_atomic_add v5, off, s[48:51], s69 sc0 sc1
  s_mov_b64 exec, -1
  s_waitcnt vmcnt(0)
  v_mov_b32 v9, s61
  s_mov_b64 exec, 3
  buffer_atomic_add v9, v4, s[48:51], s77 offen sc1
  s_mov_b64 exec, -1
  s_mov_b32 s61, 0
  v_readfirstlane_b32 s63, v5
  s_bitcmp1_b32 s63, 4
  s_cbranch_scc1 BK_124
RP_125:
  v_mov_b32 v5, 0
  s_mov_b64 exec, 1
  buffer_atomic_add v5, off, s[48:51], s69 sc0 sc1
  s_mov_b64 exec, -1
  s_waitcnt vmcnt(0)
  v_readfirstlane_b32 s63, v5
  s_bitcmp1_b32 s63, 4
  s_cbranch_scc1 BK_124
  s_sub_u32 s12, s12, 1
  s_cbranch_scc0 RP_125
  s_mov_b32 s12, 0
  s_branch BK_124
SL_126:
RP_128:
  v_mov_b32 v5, 0
  s_mov_b64 exec, 1
  buffer_atomic_add v5, off, s[48:51], s69 sc0 sc1
  s_mov_b64 exec, -1
  s_waitcnt vmcnt(0)
  v_readfirstlane_b32 s63, v5
  s_bitcmp1_b32 s63, 12
  s_cbranch_scc1 BK_127
  s_sub_u32 s12, s12, 1
  s_cbranch_scc0 RP_128
  s_mov_b32 s12, 0
  s_branch BK_127
SL_129:
RP_131:
  v_mov_b32 v5, 0
  s_mov_b64 exec, 1
  buffer_atomic_add v5, off, s[48:51], s69 sc0 sc1
  s_mov_b64 exec, -1
  s_waitcnt vmcnt(0)
  v_readfirstlane_b32 s63, v5
  s_bitcmp1_b32 s63, 20
  s_cbranch_scc1 BK_130
  s_sub_u32 s12, s12, 1
  s_cbranch_scc0 RP_131
  s_mov_b32 s12, 0
  s_branch BK_130
SL_134:
SP_136:
  ds_read_b32 v9, v8 offset:32
  s_waitcnt lgkmcnt(0)
  v_cmp_ne_u32 vcc, 0, v9
  s_cbranch_vccz SO_137
  s_sleep 2
  s_sub_u32 s12, s12, 1
  s_cbranch_scc0 SP_136
  s_mov_b32 s12, 0
SO_137:
  ds_read_b128 v[32:35], v2 offset:20480
  ds_read_b128 v[36:39], v2 offset:21504
  ds_read_b128 v[40:43], v2 offset:22528
  ds_read_b128 v[44:47], v2 offset:23552
  ds_read_b128 v[48:51], v2 offset:24576
  s_waitcnt lgkmcnt(0)
  s_branch BK_135
SL_138:
SP_140:
  ds_read_b32 v9, v8 offset:356
  s_waitcnt lgkmcnt(0)
  v_cmp_ne_u32 vcc, 0, v9
  s_cbranch_vccz SO_141
  s_sleep 2
  s_sub_u32 s12, s12, 1
  s_cbranch_scc0 SP_140
  s_mov_b32 s12, 0
SO_141:
  ds_read_b128 v[32:35], v2 offset:0
  ds_read_b128 v[36:39], v2 offset:1024
  ds_read_b128 v[40:43], v2 offset:2048
  ds_read_b128 v[44:47], v2 offset:3072
  ds_read_b128 v[48:51], v2 offset:4096
  s_waitcnt lgkmcnt(0)
  s_branch BK_139
SL_142:
SP_144:
  ds_read_b32 v9, v8 offset:36
  s_waitcnt lgkmcnt(0)
  v_cmp_ne_u32 vcc, 0, v9
  s_cbranch_vccz SO_145
  s_sleep 2
  s_sub_u32 s12, s12, 1
  s_cbranch_scc0 SP_144
  s_mov_b32 s12, 0
SO_145:
  ds_read_b128 v[32:35], v2 offset:20480
  ds_read_b128 v[36:39], v2 offset:21504
  ds_read_b128 v[40:43], v2 offset:22528
  ds_read_b128 v[44:47], v2 offset:23552
  ds_read_b128 v[48:51], v2 offset:24576
  s_waitcnt lgkmcnt(0)
  s_branch BK_143
SL_146:
SP_148:
  ds_read_b32 v9, v8 offset:360
  s_waitcnt lgkmcnt(0)
  v_cmp_ne_u32 vcc, 0, v9
  s_cbranch_vccz SO_149
  s_sleep 2
  s_sub_u32 s12, s12, 1
  s_cbranch_scc0 SP_148
  s_mov_b32 s12, 0
SO_149:
  ds_read_b128 v[32:35], v2 offset:0
  ds_read_b128 v[36:39], v2 offset:1024
  ds_read_b128 v[40:43], v2 offset:2048
  ds_read_b128 v[44:47], v2 offset:3072
  ds_read_b128 v[48:51], v2 offset:4096
  s_waitcnt lgkmcnt(0)
  s_branch BK_147
SL_150:
SP_152:
  ds_read_b32 v9, v8 offset:40
  s_waitcnt lgkmcnt(0)
  v_cmp_ne_u32 vcc, 0, v9
  s_cbranch_vccz SO_153
  s_sleep 2
  s_sub_u32 s12, s12, 1
  s_cbranch_scc0 SP_152
  s_mov_b32 s12, 0
SO_153:
  ds_read_b128 v[32:35], v2 offset:20480
  ds_read_b128 v[36:39], v2 offset:21504
  ds_read_b128 v[40:43], v2 offset:22528
  ds_read_b128 v[44:47], v2 offset:23552
  ds_read_b128 v[48:51], v2 offset:24576
  s_waitcnt lgkmcnt(0)
  s_branch BK_151
SL_154:
SP_156:
  ds_read_b32 v9, v8 offset:364
  s_waitcnt lgkmcnt(0)
  v_cmp_ne_u32 vcc, 0, v9
  s_cbranch_vccz SO_157
  s_sleep 2
  s_sub_u32 s12, s12, 1
  s_cbranch_scc0 SP_156
  s_mov_b32 s12, 0
SO_157:
  ds_read_b128 v[32:35], v2 offset:0
  ds_read_b128 v[36:39], v2 offset:1024
  ds_read_b128 v[40:43], v2 offset:2048
  ds_read_b128 v[44:47], v2 offset:3072
  ds_read_b128 v[48:51], v2 offset:4096
  s_waitcnt lgkmcnt(0)
  s_branch BK_155
SL_158:
SP_160:
  ds_read_b32 v9, v8 offset:44
  s_waitcnt lgkmcnt(0)
  v_cmp_ne_u32 vcc, 0, v9
  s_cbranch_vccz SO_161
  s_sleep 2
  s_sub_u32 s12, s12, 1
  s_cbranch_scc0 SP_160
  s_mov_b32 s12, 0
SO_161:
  ds_read_b128 v[32:35], v2 offset:20480
  ds_read_b128 v[36:39], v2 offset:21504
  ds_read_b128 v[40:43], v2 offset:22528
  ds_read_b128 v[44:47], v2 offset:23552
  ds_read_b128 v[48:51], v2 offset:24576
  s_waitcnt lgkmcnt(0)
  s_branch BK_159
SL_162:
SP_164:
  ds_read_b32 v9, v8 offset:368
  s_waitcnt lgkmcnt(0)
  v_cmp_ne_u32 vcc, 0, v9
  s_cbranch_vccz SO_165
  s_sleep 2
  s_sub_u32 s12, s12, 1
  s_cbranch_scc0 SP_164
  s_mov_b32 s12, 0
SO_165:
  ds_read_b128 v[32:35], v2 offset:0
  ds_read_b128 v[36:39], v2 offset:1024
  ds_read_b128 v[40:43], v2 offset:2048
  ds_read_b128 v[44:47], v2 offset:3072
  ds_read_b128 v[48:51], v2 offset:4096
  s_waitcnt lgkmcnt(0)
  s_branch BK_163
SL_166:
SP_168:
  ds_read_b32 v9, v8 offset:48
  s_waitcnt lgkmcnt(0)
  v_cmp_ne_u32 vcc, 0, v9
  s_cbranch_vccz SO_169
  s_sleep 2
  s_sub_u32 s12, s12, 1
  s_cbranch_scc0 SP_168
  s_mov_b32 s12, 0
SO_169:
  ds_read_b128 v[32:35], v2 offset:20480
  ds_read_b128 v[36:39], v2 offset:21504
  ds_read_b128 v[40:43], v2 offset:22528
  ds_read_b128 v[44:47], v2 offset:23552
  ds_read_b128 v[48:51], v2 offset:24576
  s_waitcnt lgkmcnt(0)
  s_branch BK_167
SL_170:
SP_172:
  ds_read_b32 v9, v8 offset:372
  s_waitcnt lgkmcnt(0)
  v_cmp_ne_u32 vcc, 0, v9
  s_cbranch_vccz SO_173
  s_sleep 2
  s_sub_u32 s12, s12, 1
  s_cbranch_scc0 SP_172
  s_mov_b32 s12, 0
SO_173:
  ds_read_b128 v[52:55], v2 offset:0
  ds_read_b128 v[56:59], v2 offset:1024
  ds_read_b128 v[60:63], v2 offset:2048
  ds_read_b128 v[64:67], v2 offset:3072
  ds_read_b128 v[68:71], v2 offset:4096
  s_waitcnt lgkmcnt(0)
  s_branch BK_171
SL_174:
SP_176:
  ds_read_b32 v9, v8 offset:52
  s_waitcnt lgkmcnt(0)
  v_cmp_ne_u32 vcc, 0, v9
  s_cbranch_vccz SO_177
  s_sleep 2
  s_sub_u32 s12, s12, 1
  s_cbranch_scc0 SP_176
  s_mov_b32 s12, 0
SO_177:
  ds_read_b128 v[52:55], v2 offset:10240
  ds_read_b128 v[56:59], v2 offset:11264
  ds_read_b128 v[60:63], v2 offset:12288
  ds_read_b128 v[64:67], v2 offset:13312
  ds_read_b128 v[68:71], v2 offset:14336
  s_waitcnt lgkmcnt(0)
  s_branch BK_175
SL_178:
SP_180:
  ds_read_b32 v9, v8 offset:56
  s_waitcnt lgkmcnt(0)
  v_cmp_ne_u32 vcc, 0, v9
  s_cbranch_vccz SO_181
  s_sleep 2
  s_sub_u32 s12, s12, 1
  s_cbranch_scc0 SP_180
  s_mov_b32 s12, 0
SO_181:
  ds_read_b64_tr_b16 v[112:113], v4 offset:0
  ds_read_b64_tr_b16 v[116:117], v4 offset:2048
  ds_read_b64_tr_b16 v[120:121], v4 offset:4096
  ds_read_b64_tr_b16 v[124:125], v4 offset:6144
  ds_read_b64_tr_b16 v[128:129], v137 offset:0
  s_waitcnt lgkmcnt(0)
  s_branch BK_179
.p2align 6
R_p:
  s_setprio 0
  s_barrier
  s_mov_b32 s12, 0x400000
  s_mul_i32 s9, s4, 43
  s_lshr_b32 s9, s9, 7
  s_mul_i32 s10, s9, 3
  s_sub_u32 s6, s4, s10
  s_lshr_b32 s6, s4, 3
  s_cmp_eq_u32 s6, 3
  s_cselect_b32 s6, 2, s6
  s_mov_b32 s48, s44
  s_and_b32 s49, s45, 0xffff
  s_mov_b32 s50, 16842752
  s_mov_b32 s51, 0x20000
  s_mul_i32 s61, s60, 6400
  s_add_u32 s61, s61, 15360
  s_mul_i32 s13, s5, 3
  s_add_u32 s13, s13, s60
  s_lshl_b32 s13, s13, 10
  s_add_u32 s13, s13, 16793600
  s_and_b32 s63, s8, 7
  s_mul_i32 s63, s63, 3
  s_lshr_b32 s63, s63, 3
  s_lshl_b32 s63, s63, 1
  s_lshr_b32 s77, s8, 3
  s_add_u32 s77, s77, s63
  s_sub_u32 s63, s77, 5
  s_cselect_b32 s77, s77, s63
  s_bfe_u32 s63, s2, 0x10001
  s_mul_i32 s46, s63, 40960
  s_add_u32 s46, s46, 40960
  s_lshl_b32 s63, s63, 2
  v_mov_b32 v226, s63
  v_bfe_u32 v2, v0, 2, 2
  v_lshrrev_b32 v3, 4, v0
  v_lshl_add_u32 v3, v3, 3, v2
  v_bfe_u32 v4, v0, 1, 1
  v_and_b32 v5, 1, v0
  v_lshlrev_b32 v5, 3, v5
  v_lshl_add_u32 v5, v3, 7, v5
  v_bfe_u32 v2, v3, 1, 3
  s_and_b32 s63, s5, 3
  s_mul_i32 s63, s63, 5
  s_add_u32 s63, s63, s60
  s_add_u32 s63, s63, 0
  s_min_u32 s63, s63, 19
  s_lshr_b32 s64, s63, 2
  s_sub_u32 s64, s64, s77
  s_cselect_b32 s65, 5, 0
  s_add_u32 s64, s64, s65
  s_lshl_b32 s64, s64, 13
  s_add_u32 s64, s64, s46
  s_and_b32 s63, s63, 3
  s_lshl_b32 s63, s63, 1
  v_add_u32 v6, s63, v4
  v_xor_b32 v6, v6, v2
  v_add_u32 v7, s64, v5
  v_xor_b32 v8, 0, v6
  v_lshl_add_u32 v8, v8, 4, v7
  v_xor_b32 v9, 2, v6
  v_lshl_add_u32 v9, v9, 4, v7
  s_add_u32 s63, s60, 0
  s_mul_i32 s78, s63, 67584
  s_mul_i32 s65, s5, 337920
  s_add_u32 s78, s78, s65
  s_lshl_b32 s65, s4, 7
  s_add_u32 s78, s78, s65
  s_add_u32 s78, s78, 8388608
  s_cmp_ge_u32 s63, 5
  s_cselect_b32 s78, 16842752, s78
  s_lshl_b32 s47, s60, 2
  v_and_b32 v13, 3, v0
  v_lshlrev_b32 v13, 2, v13
  v_lshrrev_b32 v5, 4, v0
  v_and_b32 v2, 7, v0
  v_lshl_add_u32 v2, v5, 3, v2
  v_bfe_u32 v4, v0, 3, 1
  v_lshl_add_u32 v2, v4, 5, v2
  v_lshlrev_b32 v12, 3, v2
  v_and_b32 v14, 15, v0
  v_mul_u32_u24 v14, 4224, v14
  v_lshl_add_u32 v14, v5, 4, v14
  v_mov_b32 v15, s47
  v_mov_b32 v1, 0
  v_mov_b32 v2, 8
  v_mov_b32 v3, 0
  s_mov_b64 exec, 1
  ds_write_b32 v2, v3 offset:1280
  s_mov_b64 exec, -1
  v_mov_b32 v3, 0
  s_mov_b64 exec, 1
  ds_write_b32 v2, v3 offset:1296
  s_mov_b64 exec, -1
SP_182:
  ds_read_b32 v3, v226 offset:1024
  s_waitcnt lgkmcnt(0)
  v_cmp_ne_u32 vcc, 0, v3
  s_cbranch_vccz SO_183
  s_sleep 2
  s_sub_u32 s12, s12, 1
  s_cbranch_scc0 SP_182
  s_mov_b32 s12, 0
SO_183:
  ds_read_b64_tr_b16 v[208:209], v8 offset:0
  ds_read_b64_tr_b16 v[210:211], v9 offset:512
  ds_read_b64_tr_b16 v[212:213], v8 offset:4096
  ds_read_b64_tr_b16 v[214:215], v9 offset:4608
  s_mov_b64 exec, 1
  ds_write_b32 v15, v1 offset:1264
  s_mov_b64 exec, -1
  ds_read_b32 v3, v13 offset:1104
  ds_read_b64 v[4:5], v12 offset:0
  ds_read_b64 v[6:7], v12 offset:512
  s_waitcnt lgkmcnt(7)
  v_lshlrev_b32 v164, 16, v208
  v_and_b32 v165, 0xffff0000, v208
  v_lshlrev_b32 v166, 16, v209
  v_and_b32 v167, 0xffff0000, v209
  s_waitcnt lgkmcnt(6)
  v_lshlrev_b32 v168, 16, v210
  v_and_b32 v169, 0xffff0000, v210
  v_lshlrev_b32 v170, 16, v211
  v_and_b32 v171, 0xffff0000, v211
  s_waitcnt lgkmcnt(5)
  v_lshlrev_b32 v172, 16, v212
  v_and_b32 v173, 0xffff0000, v212
  v_lshlrev_b32 v174, 16, v213
  v_and_b32 v175, 0xffff0000, v213
  s_waitcnt lgkmcnt(4)
  v_lshlrev_b32 v176, 16, v214
  v_and_b32 v177, 0xffff0000, v214
  v_lshlrev_b32 v178, 16, v215
  v_and_b32 v179, 0xffff0000, v215
  s_waitcnt lgkmcnt(2)
  v_cmp_ne_u32 vcc, 0, v3
  s_cbranch_vccnz SL_188
BK_189:
  s_waitcnt lgkmcnt(0)
  v_add_f32 v4, v4, v6
  v_add_f32 v5, v5, v7
  v_mul_f32 v6, 0x3acccccd, v4
  v_mul_f32 v7, 0x3acccccd, v5
  v_fma_f32 v7, -v6, v6, v7
  v_max_f32 v7, 0, v7
  v_cvt_pk_bf16_f32 v8, 0, v6
  v_cvt_pk_bf16_f32 v9, 0, v7
  v_add_f32 v9, 0x3727c5ac, v9
  v_cvt_pk_bf16_f32 v9, 0, v9
  v_sqrt_f32 v9, v9
  s_nop 0
  v_cvt_pk_bf16_f32 v9, 0, v9
  v_rcp_f32 v10, v9
  v_subrev_f32_dpp v164, v8, v164 row_newbcast:0 row_mask:0xf bank_mask:0xf
  v_subrev_f32_dpp v165, v8, v165 row_newbcast:1 row_mask:0xf bank_mask:0xf
  v_subrev_f32_dpp v166, v8, v166 row_newbcast:2 row_mask:0xf bank_mask:0xf
  v_subrev_f32_dpp v167, v8, v167 row_newbcast:3 row_mask:0xf bank_mask:0xf
  v_subrev_f32_dpp v168, v8, v168 row_newbcast:4 row_mask:0xf bank_mask:0xf
  v_subrev_f32_dpp v169, v8, v169 row_newbcast:5 row_mask:0xf bank_mask:0xf
  v_subrev_f32_dpp v170, v8, v170 row_newbcast:6 row_mask:0xf bank_mask:0xf
  v_subrev_f32_dpp v171, v8, v171 row_newbcast:7 row_mask:0xf bank_mask:0xf
  v_mul_f32_dpp v164, v10, v164 row_newbcast:0 row_mask:0xf bank_mask:0xf
  v_mul_f32_dpp v165, v10, v165 row_newbcast:1 row_mask:0xf bank_mask:0xf
  v_mul_f32_dpp v166, v10, v166 row_newbcast:2 row_mask:0xf bank_mask:0xf
  v_mul_f32_dpp v167, v10, v167 row_newbcast:3 row_mask:0xf bank_mask:0xf
  v_mul_f32_dpp v168, v10, v168 row_newbcast:4 row_mask:0xf bank_mask:0xf
  v_mul_f32_dpp v169, v10, v169 row_newbcast:5 row_mask:0xf bank_mask:0xf
  v_mul_f32_dpp v170, v10, v170 row_newbcast:6 row_mask:0xf bank_mask:0xf
  v_mul_f32_dpp v171, v10, v171 row_newbcast:7 row_mask:0xf bank_mask:0xf
  v_cvt_pk_bf16_f32 v208, v164, v165
  v_cvt_pk_bf16_f32 v209, v166, v167
  v_cvt_pk_bf16_f32 v210, v168, v169
  v_cvt_pk_bf16_f32 v211, v170, v171
  buffer_store_dwordx4 v[208:211], v14, s[48:51], s78 offen offset:0 sc1
  v_subrev_f32_dpp v172, v8, v172 row_newbcast:8 row_mask:0xf bank_mask:0xf
  v_subrev_f32_dpp v173, v8, v173 row_newbcast:9 row_mask:0xf bank_mask:0xf
  v_subrev_f32_dpp v174, v8, v174 row_newbcast:10 row_mask:0xf bank_mask:0xf
  v_subrev_f32_dpp v175, v8, v175 row_newbcast:11 row_mask:0xf bank_mask:0xf
  v_subrev_f32_dpp v176, v8, v176 row_newbcast:12 row_mask:0xf bank_mask:0xf
  v_subrev_f32_dpp v177, v8, v177 row_newbcast:13 row_mask:0xf bank_mask:0xf
  v_subrev_f32_dpp v178, v8, v178 row_newbcast:14 row_mask:0xf bank_mask:0xf
  v_subrev_f32_dpp v179, v8, v179 row_newbcast:15 row_mask:0xf bank_mask:0xf
  v_mul_f32_dpp v172, v10, v172 row_newbcast:8 row_mask:0xf bank_mask:0xf
  v_mul_f32_dpp v173, v10, v173 row_newbcast:9 row_mask:0xf bank_mask:0xf
  v_mul_f32_dpp v174, v10, v174 row_newbcast:10 row_mask:0xf bank_mask:0xf
  v_mul_f32_dpp v175, v10, v175 row_newbcast:11 row_mask:0xf bank_mask:0xf
  v_mul_f32_dpp v176, v10, v176 row_newbcast:12 row_mask:0xf bank_mask:0xf
  v_mul_f32_dpp v177, v10, v177 row_newbcast:13 row_mask:0xf bank_mask:0xf
  v_mul_f32_dpp v178, v10, v178 row_newbcast:14 row_mask:0xf bank_mask:0xf
  v_mul_f32_dpp v179, v10, v179 row_newbcast:15 row_mask:0xf bank_mask:0xf
  v_cvt_pk_bf16_f32 v212, v172, v173
  v_cvt_pk_bf16_f32 v213, v174, v175
  v_cvt_pk_bf16_f32 v214, v176, v177
  v_cvt_pk_bf16_f32 v215, v178, v179
  buffer_store_dwordx4 v[212:215], v14, s[48:51], s78 offen offset:64 sc1
  v_and_b32 v225, 7, v0
  v_lshlrev_b32 v225, 2, v225
  global_load_dword v224, v225, s[42:43] sc1
  s_waitcnt vmcnt(1)
  s_waitcnt vmcnt(0)
  v_cmp_eq_u32 vcc, 0, v224
  s_cbranch_vccnz SL_184
BK_185:
  v_mov_b32 v224, 1
  v_lshlrev_b32 v225, 7, v0
  s_mov_b64 exec, 255
  buffer_atomic_add v224, v225, s[48:51], s13 offen sc1
  s_mov_b64 exec, -1
  s_endpgm
SL_184:
  v_and_b32 v225, 7, v0
  v_lshlrev_b32 v225, 2, v225
SP_186:
  global_load_dword v224, v225, s[42:43] sc1
  s_waitcnt vmcnt(0)
  v_cmp_eq_u32 vcc, 0, v224
  s_cbranch_vccz SO_187
  s_sleep 1
  s_sub_u32 s12, s12, 1
  s_cbranch_scc0 SP_186
  s_mov_b32 s12, 0
SO_187:
  s_branch BK_185
SL_188:
SP_190:
  ds_read_b32 v3, v13 offset:1104
  s_waitcnt lgkmcnt(0)
  v_cmp_ne_u32 vcc, 0, v3
  s_cbranch_vccz SO_191
  s_sleep 2
  s_sub_u32 s12, s12, 1
  s_cbranch_scc0 SP_190
  s_mov_b32 s12, 0
SO_191:
  ds_read_b64 v[4:5], v12 offset:0
  ds_read_b64 v[6:7], v12 offset:512
  s_waitcnt lgkmcnt(0)
  s_branch BK_189
K_last:
  s_endpgm
.section .rodata,"a"
.p2align 6
.amdhsa_kernel parallel_sum__ssm_conv_s4d__mixer_channel_mlp__prompt_kernel
  .amdhsa_next_free_vgpr 256
  .amdhsa_next_free_sgpr 102
  .amdhsa_accum_offset 256
  .amdhsa_group_segment_fixed_size 0
  .amdhsa_kernarg_size 120
  .amdhsa_user_sgpr_count 2
  .amdhsa_user_sgpr_kernarg_segment_ptr 1
  .amdhsa_system_sgpr_workgroup_id_x 1
.end_amdhsa_kernel
```
